```python
import torch

def _softmax(x, axis=-1):
    return torch.softmax(x, dim=axis)
def _gelu(x):
    return torch.nn.functional.gelu(x, approximate="tanh")
def _silu(x):
    return torch.nn.functional.silu(x)
def _sigmoid(x):
    return torch.sigmoid(x)
def _layernorm(x, axis=-1, eps=1e-5):
    m = x.mean(dim=axis, keepdim=True)
    v = x.var(dim=axis, keepdim=True, unbiased=False)
    return (x - m) / torch.sqrt(v + eps)
def _scatter_add(tgt, idx, src, axis=0):
    return tgt.clone().index_add_(axis, idx, src)
def _segment_sum(src, seg, n):
    out = torch.zeros((n,) + src.shape[1:], dtype=src.dtype)
    return out.index_add_(0, seg, src)
def _pad(x, pw):
    flat = tuple(v for pair in reversed(pw) for v in pair)
    return torch.nn.functional.pad(x, flat)

kernel_name = 'sequential_preLN__mha_block_cached__glu_gated_swiglu__decode'

def setup_inputs():

    _w = (lambda a: (lambda t: t.to(torch.bfloat16) if t.is_floating_point() else t)(torch.as_tensor(a)))
    def _A_setup():
        B, Sq, D = 4, 1, 448
        H, Sk, Dh = 16, 4096, 256
        return {
            "x": _w((lambda *s: torch.randn(*s, dtype=torch.bfloat16) * 0.05)(B, Sq, D)),
            "k_cache": _w((lambda *s: torch.randn(*s, dtype=torch.bfloat16) * 1.6)(B, H, Sk, Dh)),
            "v_cache": _w((lambda *s: torch.randn(*s, dtype=torch.bfloat16) * 0.8)(B, H, Sk, Dh)),
            "wq": _w((lambda *s: torch.randn(*s, dtype=torch.bfloat16) * 1.6)(D, H * Dh) * (D ** -0.5)),
            "wo": _w((lambda *s: torch.randn(*s, dtype=torch.bfloat16) * 0.8)(H * Dh, D) * ((H * Dh) ** -0.5)),
        }
    _A_in = _A_setup()

    def _B_setup():
        B, S, D, F = 4, 1, 448, 1792
        return {
            "x": _w((lambda *s: torch.randn(*s, dtype=torch.bfloat16) * 0.05)(B, S, D)),
            "w1": _w((lambda *s: torch.randn(*s, dtype=torch.bfloat16) * 0.4)(D, F) * (2.0 / D) ** 0.5),
            "w3": _w((lambda *s: torch.randn(*s, dtype=torch.bfloat16) * 0.4)(D, F) * (2.0 / D) ** 0.5),
            "w2": _w((lambda *s: torch.randn(*s, dtype=torch.bfloat16) * 0.4)(F, D) * (2.0 / F) ** 0.5),
        }
    _B_in = _B_setup()

    return {
        "A_x": _A_in["x"],
        "A_k_cache": _A_in["k_cache"],
        "A_v_cache": _A_in["v_cache"],
        "A_wq": _A_in["wq"],
        "A_wo": _A_in["wo"],
        "B_x": _B_in["x"],
        "B_w1": _B_in["w1"],
        "B_w3": _B_in["w3"],
        "B_w2": _B_in["w2"],
    }

def reference(A_x, A_k_cache, A_v_cache, A_wq, A_wo, B_x, B_w1, B_w3, B_w2):
    def _A_ref(x, k_cache, v_cache, wq, wo):
        B, Sq, D = x.shape
        H, Dh = 16, 256
        q = (lambda x, *d: x.permute(*d))((x @ wq).reshape(B, Sq, H, Dh), 0, 2, 1, 3)
        scores = torch.einsum("bhqd,bhkd->bhqk", q, k_cache) * (Dh ** -0.5)
        p = _softmax(scores, axis=-1)
        o = torch.einsum("bhqk,bhkd->bhqd", p, v_cache)
        return (lambda x, *d: x.permute(*d))(o, 0, 2, 1, 3).reshape(B, Sq, H * Dh) @ wo

    def _B_ref(x, w1, w3, w2):
        gate = torch.einsum("bsd,df->bsf", x, w1)
        up = torch.einsum("bsd,df->bsf", x, w3)
        h = _silu(gate) * up
        out = torch.einsum("bsf,fd->bsd", h, w2)
        return out

    x = A_x
    h = x + _A_ref(_layernorm(x, axis=-1), A_k_cache, A_v_cache, A_wq, A_wo)
    h2 = h + _B_ref(_layernorm(h, axis=-1), B_w1, B_w3, B_w2)
    return h2
```

```asm
; @launch grid=(256,1,1) block=(512,1,1) lds=155648
.amdgcn_target "amdgcn-amd-amdhsa--gfx950"
.text
.globl sequential_preLN__mha_block_cached__glu_gated_swiglu__decode_kernel
.p2align 8
.type sequential_preLN__mha_block_cached__glu_gated_swiglu__decode_kernel,@function
sequential_preLN__mha_block_cached__glu_gated_swiglu__decode_kernel:
    s_cmp_ge_u32 s2, 256
    s_cbranch_scc1 L_exit
    s_load_dwordx16 s[16:31], s[0:1], 0
    s_load_dwordx8 s[32:39], s[0:1], 64
    v_lshrrev_b32 v2, 6, v0
    v_and_b32 v1, 63, v0
    v_lshlrev_b32 v10, 2, v1
    v_mov_b32 v16, 0
    v_readfirstlane_b32 s3, v2
    ds_write_b32 v10, v16 offset:16896
    s_bfe_u32 s4, s2, 0x20001
    s_and_b32 s9, s2, 1
    s_lshr_b32 s10, s2, 5
    s_lshl1_add_u32 s6, s10, s9
    s_bfe_u32 s5, s2, 0x20003
    s_lshl4_add_u32 s7, s5, s6
    v_lshrrev_b32 v3, 3, v1
    v_and_b32 v4, 7, v1
    s_lshl2_add_u32 s10, s7, s4
    s_lshl_b32 s10, s10, 19
    v_lshlrev_b32 v6, 9, v3
    v_lshl_add_u32 v6, v4, 4, v6
    v_lshl_add_u32 v5, v2, 12, v6
    s_mov_b32 s42, 524288
    s_mov_b32 s43, 0x20000
    s_cmp_ge_u32 s3, 4
    s_waitcnt lgkmcnt(0)
    s_barrier
    s_cbranch_scc1 L_service
    s_add_u32 s40, s18, s10
    s_addc_u32 s41, s19, 0
    s_mov_b32 s48, 0
    buffer_load_dwordx4 v[48:51], v5, s[40:43], s48 offen offset:0 nt
    buffer_load_dwordx4 v[52:55], v5, s[40:43], s48 offen offset:128 nt
    buffer_load_dwordx4 v[56:59], v5, s[40:43], s48 offen offset:256 nt
    buffer_load_dwordx4 v[60:63], v5, s[40:43], s48 offen offset:384 nt
    s_mov_b32 s48, 16384
    buffer_load_dwordx4 v[64:67], v5, s[40:43], s48 offen offset:0 nt
    buffer_load_dwordx4 v[68:71], v5, s[40:43], s48 offen offset:128 nt
    buffer_load_dwordx4 v[72:75], v5, s[40:43], s48 offen offset:256 nt
    buffer_load_dwordx4 v[76:79], v5, s[40:43], s48 offen offset:384 nt
L_p1:
    s_andn2_b32 s8, s2, 24
    s_mov_b32 s62, s3
    s_mov_b32 s12, s38
    s_mov_b32 s13, s39
    s_mov_b32 s14, 4194304
    s_mov_b32 s15, 0x20000
    s_lshl_b32 s9, s7, 21
    s_lshl_b32 s10, s4, 7
    s_sub_u32 s11, 2097152, s10
    s_add_u32 s10, s10, s9
    s_add_u32 s44, s20, s10
    s_addc_u32 s45, s21, 0
    s_mov_b32 s46, s11
    s_mov_b32 s47, 0x20000
    v_lshl_add_u32 v6, v2, 14, v6
    v_add_u32 v7, 4096, v6
    v_add_u32 v8, 8192, v6
    v_add_u32 v9, 12288, v6
    s_lshl_b32 s49, s7, 13
    s_lshl_b32 s9, s4, 11
    s_add_u32 s49, s49, s9
    s_lshl_b32 s9, s3, 9
    s_add_u32 s49, s49, s9
    s_add_u32 s49, s49, 262144
    v_lshlrev_b32 v11, 4, v3
    s_lshl_b32 s9, s3, 7
    v_add_u32 v11, s9, v11
    s_mov_b32 s64, 0x1010101
    s_mov_b32 s65, 0x1010101
    s_mov_b32 s66, 0x2020202
    s_mov_b32 s67, 0x2020202
    s_mov_b32 s68, 0x4040404
    s_mov_b32 s69, 0x4040404
    s_mov_b32 s70, 0x8080808
    s_mov_b32 s71, 0x8080808
    s_mov_b32 s72, 0x10101010
    s_mov_b32 s73, 0x10101010
    s_mov_b32 s74, 0x20202020
    s_mov_b32 s75, 0x20202020
    s_mov_b32 s76, 0x40404040
    s_mov_b32 s77, 0x40404040
    s_mov_b32 s78, 0x80808080
    s_mov_b32 s79, 0x80808080
    v_mov_b32 v17, 0
    s_mov_b32 s48, 32768
    s_waitcnt vmcnt(7)
    buffer_load_dwordx4 v[80:83], v5, s[40:43], s48 offen offset:0 nt
    s_waitcnt vmcnt(7)
    buffer_load_dwordx4 v[84:87], v5, s[40:43], s48 offen offset:128 nt
    s_waitcnt vmcnt(7)
    buffer_load_dwordx4 v[88:91], v5, s[40:43], s48 offen offset:256 nt
    s_waitcnt vmcnt(7)
    buffer_load_dwordx4 v[92:95], v5, s[40:43], s48 offen offset:384 nt
    s_mov_b32 s48, 49152
    s_waitcnt vmcnt(7)
    buffer_load_dwordx4 v[96:99], v5, s[40:43], s48 offen offset:0 nt
    s_waitcnt vmcnt(7)
    buffer_load_dwordx4 v[100:103], v5, s[40:43], s48 offen offset:128 nt
    s_waitcnt vmcnt(7)
    buffer_load_dwordx4 v[104:107], v5, s[40:43], s48 offen offset:256 nt
    s_waitcnt vmcnt(7)
    buffer_load_dwordx4 v[108:111], v5, s[40:43], s48 offen offset:384 nt
    s_mov_b32 s48, 65536
    s_waitcnt vmcnt(7)
    buffer_load_dwordx4 v[112:115], v5, s[40:43], s48 offen offset:0 nt
    s_waitcnt vmcnt(7)
    buffer_load_dwordx4 v[116:119], v5, s[40:43], s48 offen offset:128 nt
    s_waitcnt vmcnt(7)
    buffer_load_dwordx4 v[120:123], v5, s[40:43], s48 offen offset:256 nt
    s_waitcnt vmcnt(7)
    buffer_load_dwordx4 v[124:127], v5, s[40:43], s48 offen offset:384 nt
    s_mov_b32 s48, 81920
    s_waitcnt vmcnt(7)
    buffer_load_dwordx4 v[128:131], v5, s[40:43], s48 offen offset:0 nt
    s_waitcnt vmcnt(7)
    buffer_load_dwordx4 v[132:135], v5, s[40:43], s48 offen offset:128 nt
    s_waitcnt vmcnt(7)
    buffer_load_dwordx4 v[136:139], v5, s[40:43], s48 offen offset:256 nt
    s_waitcnt vmcnt(7)
    buffer_load_dwordx4 v[140:143], v5, s[40:43], s48 offen offset:384 nt
    s_mov_b32 s48, 98304
    s_waitcnt vmcnt(7)
    buffer_load_dwordx4 v[144:147], v5, s[40:43], s48 offen offset:0 nt
    s_waitcnt vmcnt(7)
    buffer_load_dwordx4 v[148:151], v5, s[40:43], s48 offen offset:128 nt
    s_waitcnt vmcnt(7)
    buffer_load_dwordx4 v[152:155], v5, s[40:43], s48 offen offset:256 nt
    s_waitcnt vmcnt(7)
    buffer_load_dwordx4 v[156:159], v5, s[40:43], s48 offen offset:384 nt
    s_mov_b32 s48, 114688
    s_waitcnt vmcnt(7)
    buffer_load_dwordx4 v[160:163], v5, s[40:43], s48 offen offset:0 nt
    s_waitcnt vmcnt(7)
    buffer_load_dwordx4 v[164:167], v5, s[40:43], s48 offen offset:128 nt
    s_waitcnt vmcnt(7)
    buffer_load_dwordx4 v[168:171], v5, s[40:43], s48 offen offset:256 nt
    s_waitcnt vmcnt(7)
    buffer_load_dwordx4 v[172:175], v5, s[40:43], s48 offen offset:384 nt
    s_mov_b32 s48, 131072
    s_waitcnt vmcnt(7)
    buffer_load_dwordx4 v[176:179], v5, s[40:43], s48 offen offset:0 nt
    s_waitcnt vmcnt(7)
    buffer_load_dwordx4 v[180:183], v5, s[40:43], s48 offen offset:128 nt
    s_waitcnt vmcnt(7)
    buffer_load_dwordx4 v[184:187], v5, s[40:43], s48 offen offset:256 nt
    s_waitcnt vmcnt(7)
    buffer_load_dwordx4 v[188:191], v5, s[40:43], s48 offen offset:384 nt
    s_mov_b32 s48, 147456
    s_waitcnt vmcnt(7)
    buffer_load_dwordx4 v[192:195], v5, s[40:43], s48 offen offset:0 nt
    s_waitcnt vmcnt(7)
    buffer_load_dwordx4 v[196:199], v5, s[40:43], s48 offen offset:128 nt
    s_waitcnt vmcnt(7)
    buffer_load_dwordx4 v[200:203], v5, s[40:43], s48 offen offset:256 nt
    s_waitcnt vmcnt(7)
    buffer_load_dwordx4 v[204:207], v5, s[40:43], s48 offen offset:384 nt
    s_mov_b32 s48, 163840
    s_waitcnt vmcnt(7)
    buffer_load_dwordx4 v[208:211], v5, s[40:43], s48 offen offset:0 nt
    s_waitcnt vmcnt(7)
    buffer_load_dwordx4 v[212:215], v5, s[40:43], s48 offen offset:128 nt
    s_waitcnt vmcnt(7)
    buffer_load_dwordx4 v[216:219], v5, s[40:43], s48 offen offset:256 nt
    s_waitcnt vmcnt(7)
    buffer_load_dwordx4 v[220:223], v5, s[40:43], s48 offen offset:384 nt
    s_mov_b32 s48, 180224
    s_waitcnt vmcnt(7)
    buffer_load_dwordx4 v[224:227], v5, s[40:43], s48 offen offset:0 nt
    s_waitcnt vmcnt(7)
    buffer_load_dwordx4 v[228:231], v5, s[40:43], s48 offen offset:128 nt
    s_waitcnt vmcnt(7)
    buffer_load_dwordx4 v[232:235], v5, s[40:43], s48 offen offset:256 nt
    s_waitcnt vmcnt(7)
    buffer_load_dwordx4 v[236:239], v5, s[40:43], s48 offen offset:384 nt
    s_mov_b32 s48, 196608
    s_waitcnt vmcnt(7)
    buffer_load_dwordx4 v[240:243], v5, s[40:43], s48 offen offset:0 nt
    s_waitcnt vmcnt(7)
    buffer_load_dwordx4 v[244:247], v5, s[40:43], s48 offen offset:128 nt
    s_waitcnt vmcnt(7)
    buffer_load_dwordx4 v[248:251], v5, s[40:43], s48 offen offset:256 nt
    s_waitcnt vmcnt(7)
    buffer_load_dwordx4 v[252:255], v5, s[40:43], s48 offen offset:384 nt
    s_barrier
    v_lshlrev_b32 v19, 4, v4
    ds_read_b128 v[32:35], v19 offset:16384
    ds_read_b128 v[36:39], v19 offset:16512
    ds_read_b128 v[40:43], v19 offset:16640
    ds_read_b128 v[44:47], v19 offset:16768
    s_waitcnt lgkmcnt(0)
    v_mov_b32 v12, 0
    v_mov_b32 v13, 0
    v_mov_b32 v14, 0
    v_mov_b32 v15, 0
    v_dot2c_f32_bf16 v12, v48, v32
    v_dot2c_f32_bf16 v13, v52, v36
    v_dot2c_f32_bf16 v14, v56, v40
    v_dot2c_f32_bf16 v15, v60, v44
    v_dot2c_f32_bf16 v12, v49, v33
    v_dot2c_f32_bf16 v13, v53, v37
    v_dot2c_f32_bf16 v14, v57, v41
    v_dot2c_f32_bf16 v15, v61, v45
    v_dot2c_f32_bf16 v12, v50, v34
    v_dot2c_f32_bf16 v13, v54, v38
    v_dot2c_f32_bf16 v14, v58, v42
    v_dot2c_f32_bf16 v15, v62, v46
    v_dot2c_f32_bf16 v12, v51, v35
    v_dot2c_f32_bf16 v13, v55, v39
    v_dot2c_f32_bf16 v14, v59, v43
    v_dot2c_f32_bf16 v15, v63, v47
    s_nop 0
    v_add_f32 v12, v12, v13
    s_nop 0
    v_add_f32 v14, v14, v15
    v_add_f32 v12, v12, v14
    s_nop 1
    v_add_f32_dpp v12, v12, v12 quad_perm:[1,0,3,2] row_mask:0xf bank_mask:0xf
    s_nop 1
    v_add_f32_dpp v12, v12, v12 quad_perm:[2,3,0,1] row_mask:0xf bank_mask:0xf
    s_nop 1
    v_add_f32_dpp v12, v12, v12 row_half_mirror row_mask:0xf bank_mask:0xf
    v_cndmask_b32 v16, v16, v12, s[64:65]
    s_mov_b32 s48, 212992
    s_waitcnt vmcnt(7)
    buffer_load_dwordx4 v[48:51], v5, s[40:43], s48 offen offset:0 nt
    s_waitcnt vmcnt(7)
    buffer_load_dwordx4 v[52:55], v5, s[40:43], s48 offen offset:128 nt
    s_waitcnt vmcnt(7)
    buffer_load_dwordx4 v[56:59], v5, s[40:43], s48 offen offset:256 nt
    s_waitcnt vmcnt(7)
    buffer_load_dwordx4 v[60:63], v5, s[40:43], s48 offen offset:384 nt
    v_mov_b32 v12, 0
    v_mov_b32 v13, 0
    v_mov_b32 v14, 0
    v_mov_b32 v15, 0
    v_dot2c_f32_bf16 v12, v64, v32
    v_dot2c_f32_bf16 v13, v68, v36
    v_dot2c_f32_bf16 v14, v72, v40
    v_dot2c_f32_bf16 v15, v76, v44
    v_dot2c_f32_bf16 v12, v65, v33
    v_dot2c_f32_bf16 v13, v69, v37
    v_dot2c_f32_bf16 v14, v73, v41
    v_dot2c_f32_bf16 v15, v77, v45
    v_dot2c_f32_bf16 v12, v66, v34
    v_dot2c_f32_bf16 v13, v70, v38
    v_dot2c_f32_bf16 v14, v74, v42
    v_dot2c_f32_bf16 v15, v78, v46
    v_dot2c_f32_bf16 v12, v67, v35
    v_dot2c_f32_bf16 v13, v71, v39
    v_dot2c_f32_bf16 v14, v75, v43
    v_dot2c_f32_bf16 v15, v79, v47
    s_nop 0
    v_add_f32 v12, v12, v13
    s_nop 0
    v_add_f32 v14, v14, v15
    v_add_f32 v12, v12, v14
    s_nop 1
    v_add_f32_dpp v12, v12, v12 quad_perm:[1,0,3,2] row_mask:0xf bank_mask:0xf
    s_nop 1
    v_add_f32_dpp v12, v12, v12 quad_perm:[2,3,0,1] row_mask:0xf bank_mask:0xf
    s_nop 1
    v_add_f32_dpp v12, v12, v12 row_half_mirror row_mask:0xf bank_mask:0xf
    v_cndmask_b32 v16, v16, v12, s[66:67]
    s_mov_b32 s48, 229376
    s_waitcnt vmcnt(7)
    buffer_load_dwordx4 v[64:67], v5, s[40:43], s48 offen offset:0 nt
    s_waitcnt vmcnt(7)
    buffer_load_dwordx4 v[68:71], v5, s[40:43], s48 offen offset:128 nt
    s_waitcnt vmcnt(7)
    buffer_load_dwordx4 v[72:75], v5, s[40:43], s48 offen offset:256 nt
    s_waitcnt vmcnt(7)
    buffer_load_dwordx4 v[76:79], v5, s[40:43], s48 offen offset:384 nt
    v_mov_b32 v12, 0
    v_mov_b32 v13, 0
    v_mov_b32 v14, 0
    v_mov_b32 v15, 0
    v_dot2c_f32_bf16 v12, v80, v32
    v_dot2c_f32_bf16 v13, v84, v36
    v_dot2c_f32_bf16 v14, v88, v40
    v_dot2c_f32_bf16 v15, v92, v44
    v_dot2c_f32_bf16 v12, v81, v33
    v_dot2c_f32_bf16 v13, v85, v37
    v_dot2c_f32_bf16 v14, v89, v41
    v_dot2c_f32_bf16 v15, v93, v45
    v_dot2c_f32_bf16 v12, v82, v34
    v_dot2c_f32_bf16 v13, v86, v38
    v_dot2c_f32_bf16 v14, v90, v42
    v_dot2c_f32_bf16 v15, v94, v46
    v_dot2c_f32_bf16 v12, v83, v35
    v_dot2c_f32_bf16 v13, v87, v39
    v_dot2c_f32_bf16 v14, v91, v43
    v_dot2c_f32_bf16 v15, v95, v47
    s_nop 0
    v_add_f32 v12, v12, v13
    s_nop 0
    v_add_f32 v14, v14, v15
    v_add_f32 v12, v12, v14
    s_nop 1
    v_add_f32_dpp v12, v12, v12 quad_perm:[1,0,3,2] row_mask:0xf bank_mask:0xf
    s_nop 1
    v_add_f32_dpp v12, v12, v12 quad_perm:[2,3,0,1] row_mask:0xf bank_mask:0xf
    s_nop 1
    v_add_f32_dpp v12, v12, v12 row_half_mirror row_mask:0xf bank_mask:0xf
    v_cndmask_b32 v16, v16, v12, s[68:69]
    s_mov_b32 s48, 245760
    s_waitcnt vmcnt(7)
    buffer_load_dwordx4 v[80:83], v5, s[40:43], s48 offen offset:0 nt
    s_waitcnt vmcnt(7)
    buffer_load_dwordx4 v[84:87], v5, s[40:43], s48 offen offset:128 nt
    s_waitcnt vmcnt(7)
    buffer_load_dwordx4 v[88:91], v5, s[40:43], s48 offen offset:256 nt
    s_waitcnt vmcnt(7)
    buffer_load_dwordx4 v[92:95], v5, s[40:43], s48 offen offset:384 nt
    v_mov_b32 v12, 0
    v_mov_b32 v13, 0
    v_mov_b32 v14, 0
    v_mov_b32 v15, 0
    v_dot2c_f32_bf16 v12, v96, v32
    v_dot2c_f32_bf16 v13, v100, v36
    v_dot2c_f32_bf16 v14, v104, v40
    v_dot2c_f32_bf16 v15, v108, v44
    v_dot2c_f32_bf16 v12, v97, v33
    v_dot2c_f32_bf16 v13, v101, v37
    v_dot2c_f32_bf16 v14, v105, v41
    v_dot2c_f32_bf16 v15, v109, v45
    v_dot2c_f32_bf16 v12, v98, v34
    v_dot2c_f32_bf16 v13, v102, v38
    v_dot2c_f32_bf16 v14, v106, v42
    v_dot2c_f32_bf16 v15, v110, v46
    v_dot2c_f32_bf16 v12, v99, v35
    v_dot2c_f32_bf16 v13, v103, v39
    v_dot2c_f32_bf16 v14, v107, v43
    v_dot2c_f32_bf16 v15, v111, v47
    s_nop 0
    v_add_f32 v12, v12, v13
    s_nop 0
    v_add_f32 v14, v14, v15
    v_add_f32 v12, v12, v14
    s_nop 1
    v_add_f32_dpp v12, v12, v12 quad_perm:[1,0,3,2] row_mask:0xf bank_mask:0xf
    s_nop 1
    v_add_f32_dpp v12, v12, v12 quad_perm:[2,3,0,1] row_mask:0xf bank_mask:0xf
    s_nop 1
    v_add_f32_dpp v12, v12, v12 row_half_mirror row_mask:0xf bank_mask:0xf
    v_cndmask_b32 v16, v16, v12, s[70:71]
    s_mov_b32 s48, 262144
    s_waitcnt vmcnt(7)
    buffer_load_dwordx4 v[96:99], v5, s[40:43], s48 offen offset:0 nt
    s_waitcnt vmcnt(7)
    buffer_load_dwordx4 v[100:103], v5, s[40:43], s48 offen offset:128 nt
    s_waitcnt vmcnt(7)
    buffer_load_dwordx4 v[104:107], v5, s[40:43], s48 offen offset:256 nt
    s_waitcnt vmcnt(7)
    buffer_load_dwordx4 v[108:111], v5, s[40:43], s48 offen offset:384 nt
    v_mov_b32 v12, 0
    v_mov_b32 v13, 0
    v_mov_b32 v14, 0
    v_mov_b32 v15, 0
    v_dot2c_f32_bf16 v12, v112, v32
    v_dot2c_f32_bf16 v13, v116, v36
    v_dot2c_f32_bf16 v14, v120, v40
    v_dot2c_f32_bf16 v15, v124, v44
    v_dot2c_f32_bf16 v12, v113, v33
    v_dot2c_f32_bf16 v13, v117, v37
    v_dot2c_f32_bf16 v14, v121, v41
    v_dot2c_f32_bf16 v15, v125, v45
    v_dot2c_f32_bf16 v12, v114, v34
    v_dot2c_f32_bf16 v13, v118, v38
    v_dot2c_f32_bf16 v14, v122, v42
    v_dot2c_f32_bf16 v15, v126, v46
    v_dot2c_f32_bf16 v12, v115, v35
    v_dot2c_f32_bf16 v13, v119, v39
    v_dot2c_f32_bf16 v14, v123, v43
    v_dot2c_f32_bf16 v15, v127, v47
    s_nop 0
    v_add_f32 v12, v12, v13
    s_nop 0
    v_add_f32 v14, v14, v15
    v_add_f32 v12, v12, v14
    s_nop 1
    v_add_f32_dpp v12, v12, v12 quad_perm:[1,0,3,2] row_mask:0xf bank_mask:0xf
    s_nop 1
    v_add_f32_dpp v12, v12, v12 quad_perm:[2,3,0,1] row_mask:0xf bank_mask:0xf
    s_nop 1
    v_add_f32_dpp v12, v12, v12 row_half_mirror row_mask:0xf bank_mask:0xf
    v_cndmask_b32 v16, v16, v12, s[72:73]
    s_mov_b32 s48, 278528
    s_waitcnt vmcnt(7)
    buffer_load_dwordx4 v[112:115], v5, s[40:43], s48 offen offset:0 nt
    s_waitcnt vmcnt(7)
    buffer_load_dwordx4 v[116:119], v5, s[40:43], s48 offen offset:128 nt
    s_waitcnt vmcnt(7)
    buffer_load_dwordx4 v[120:123], v5, s[40:43], s48 offen offset:256 nt
    s_waitcnt vmcnt(7)
    buffer_load_dwordx4 v[124:127], v5, s[40:43], s48 offen offset:384 nt
    v_mov_b32 v12, 0
    v_mov_b32 v13, 0
    v_mov_b32 v14, 0
    v_mov_b32 v15, 0
    v_dot2c_f32_bf16 v12, v128, v32
    v_dot2c_f32_bf16 v13, v132, v36
    v_dot2c_f32_bf16 v14, v136, v40
    v_dot2c_f32_bf16 v15, v140, v44
    v_dot2c_f32_bf16 v12, v129, v33
    v_dot2c_f32_bf16 v13, v133, v37
    v_dot2c_f32_bf16 v14, v137, v41
    v_dot2c_f32_bf16 v15, v141, v45
    v_dot2c_f32_bf16 v12, v130, v34
    v_dot2c_f32_bf16 v13, v134, v38
    v_dot2c_f32_bf16 v14, v138, v42
    v_dot2c_f32_bf16 v15, v142, v46
    v_dot2c_f32_bf16 v12, v131, v35
    v_dot2c_f32_bf16 v13, v135, v39
    v_dot2c_f32_bf16 v14, v139, v43
    v_dot2c_f32_bf16 v15, v143, v47
    s_nop 0
    v_add_f32 v12, v12, v13
    s_nop 0
    v_add_f32 v14, v14, v15
    v_add_f32 v12, v12, v14
    s_nop 1
    v_add_f32_dpp v12, v12, v12 quad_perm:[1,0,3,2] row_mask:0xf bank_mask:0xf
    s_nop 1
    v_add_f32_dpp v12, v12, v12 quad_perm:[2,3,0,1] row_mask:0xf bank_mask:0xf
    s_nop 1
    v_add_f32_dpp v12, v12, v12 row_half_mirror row_mask:0xf bank_mask:0xf
    v_cndmask_b32 v16, v16, v12, s[74:75]
    s_mov_b32 s48, 294912
    s_waitcnt vmcnt(7)
    buffer_load_dwordx4 v[128:131], v5, s[40:43], s48 offen offset:0 nt
    s_waitcnt vmcnt(7)
    buffer_load_dwordx4 v[132:135], v5, s[40:43], s48 offen offset:128 nt
    s_waitcnt vmcnt(7)
    buffer_load_dwordx4 v[136:139], v5, s[40:43], s48 offen offset:256 nt
    s_waitcnt vmcnt(7)
    buffer_load_dwordx4 v[140:143], v5, s[40:43], s48 offen offset:384 nt
    v_mov_b32 v12, 0
    v_mov_b32 v13, 0
    v_mov_b32 v14, 0
    v_mov_b32 v15, 0
    v_dot2c_f32_bf16 v12, v144, v32
    v_dot2c_f32_bf16 v13, v148, v36
    v_dot2c_f32_bf16 v14, v152, v40
    v_dot2c_f32_bf16 v15, v156, v44
    v_dot2c_f32_bf16 v12, v145, v33
    v_dot2c_f32_bf16 v13, v149, v37
    v_dot2c_f32_bf16 v14, v153, v41
    v_dot2c_f32_bf16 v15, v157, v45
    v_dot2c_f32_bf16 v12, v146, v34
    v_dot2c_f32_bf16 v13, v150, v38
    v_dot2c_f32_bf16 v14, v154, v42
    v_dot2c_f32_bf16 v15, v158, v46
    v_dot2c_f32_bf16 v12, v147, v35
    v_dot2c_f32_bf16 v13, v151, v39
    v_dot2c_f32_bf16 v14, v155, v43
    v_dot2c_f32_bf16 v15, v159, v47
    s_nop 0
    v_add_f32 v12, v12, v13
    s_nop 0
    v_add_f32 v14, v14, v15
    v_add_f32 v12, v12, v14
    s_nop 1
    v_add_f32_dpp v12, v12, v12 quad_perm:[1,0,3,2] row_mask:0xf bank_mask:0xf
    s_nop 1
    v_add_f32_dpp v12, v12, v12 quad_perm:[2,3,0,1] row_mask:0xf bank_mask:0xf
    s_nop 1
    v_add_f32_dpp v12, v12, v12 row_half_mirror row_mask:0xf bank_mask:0xf
    v_cndmask_b32 v16, v16, v12, s[76:77]
    s_mov_b32 s48, 311296
    s_waitcnt vmcnt(7)
    buffer_load_dwordx4 v[144:147], v5, s[40:43], s48 offen offset:0 nt
    s_waitcnt vmcnt(7)
    buffer_load_dwordx4 v[148:151], v5, s[40:43], s48 offen offset:128 nt
    s_waitcnt vmcnt(7)
    buffer_load_dwordx4 v[152:155], v5, s[40:43], s48 offen offset:256 nt
    s_waitcnt vmcnt(7)
    buffer_load_dwordx4 v[156:159], v5, s[40:43], s48 offen offset:384 nt
    v_mov_b32 v12, 0
    v_mov_b32 v13, 0
    v_mov_b32 v14, 0
    v_mov_b32 v15, 0
    v_dot2c_f32_bf16 v12, v160, v32
    v_dot2c_f32_bf16 v13, v164, v36
    v_dot2c_f32_bf16 v14, v168, v40
    v_dot2c_f32_bf16 v15, v172, v44
    v_dot2c_f32_bf16 v12, v161, v33
    v_dot2c_f32_bf16 v13, v165, v37
    v_dot2c_f32_bf16 v14, v169, v41
    v_dot2c_f32_bf16 v15, v173, v45
    v_dot2c_f32_bf16 v12, v162, v34
    v_dot2c_f32_bf16 v13, v166, v38
    v_dot2c_f32_bf16 v14, v170, v42
    v_dot2c_f32_bf16 v15, v174, v46
    v_dot2c_f32_bf16 v12, v163, v35
    v_dot2c_f32_bf16 v13, v167, v39
    v_dot2c_f32_bf16 v14, v171, v43
    v_dot2c_f32_bf16 v15, v175, v47
    s_nop 0
    v_add_f32 v12, v12, v13
    s_nop 0
    v_add_f32 v14, v14, v15
    v_add_f32 v12, v12, v14
    s_nop 1
    v_add_f32_dpp v12, v12, v12 quad_perm:[1,0,3,2] row_mask:0xf bank_mask:0xf
    s_nop 1
    v_add_f32_dpp v12, v12, v12 quad_perm:[2,3,0,1] row_mask:0xf bank_mask:0xf
    s_nop 1
    v_add_f32_dpp v12, v12, v12 row_half_mirror row_mask:0xf bank_mask:0xf
    v_cndmask_b32 v16, v16, v12, s[78:79]
    s_mov_b32 s48, 327680
    s_waitcnt vmcnt(7)
    buffer_load_dwordx4 v[160:163], v5, s[40:43], s48 offen offset:0 nt
    s_waitcnt vmcnt(7)
    buffer_load_dwordx4 v[164:167], v5, s[40:43], s48 offen offset:128 nt
    s_waitcnt vmcnt(7)
    buffer_load_dwordx4 v[168:171], v5, s[40:43], s48 offen offset:256 nt
    s_waitcnt vmcnt(7)
    buffer_load_dwordx4 v[172:175], v5, s[40:43], s48 offen offset:384 nt
    v_mov_b32 v12, 0
    v_mov_b32 v13, 0
    v_mov_b32 v14, 0
    v_mov_b32 v15, 0
    v_dot2c_f32_bf16 v12, v176, v32
    v_dot2c_f32_bf16 v13, v180, v36
    v_dot2c_f32_bf16 v14, v184, v40
    v_dot2c_f32_bf16 v15, v188, v44
    v_dot2c_f32_bf16 v12, v177, v33
    v_dot2c_f32_bf16 v13, v181, v37
    v_dot2c_f32_bf16 v14, v185, v41
    v_dot2c_f32_bf16 v15, v189, v45
    v_dot2c_f32_bf16 v12, v178, v34
    v_dot2c_f32_bf16 v13, v182, v38
    v_dot2c_f32_bf16 v14, v186, v42
    v_dot2c_f32_bf16 v15, v190, v46
    v_dot2c_f32_bf16 v12, v179, v35
    v_dot2c_f32_bf16 v13, v183, v39
    v_dot2c_f32_bf16 v14, v187, v43
    v_dot2c_f32_bf16 v15, v191, v47
    s_nop 0
    v_add_f32 v12, v12, v13
    s_nop 0
    v_add_f32 v14, v14, v15
    v_add_f32 v12, v12, v14
    s_nop 1
    v_add_f32_dpp v12, v12, v12 quad_perm:[1,0,3,2] row_mask:0xf bank_mask:0xf
    s_nop 1
    v_add_f32_dpp v12, v12, v12 quad_perm:[2,3,0,1] row_mask:0xf bank_mask:0xf
    s_nop 1
    v_add_f32_dpp v12, v12, v12 row_half_mirror row_mask:0xf bank_mask:0xf
    v_cndmask_b32 v17, v17, v12, s[64:65]
    s_mov_b32 s48, 344064
    s_waitcnt vmcnt(7)
    buffer_load_dwordx4 v[176:179], v5, s[40:43], s48 offen offset:0 nt
    s_waitcnt vmcnt(7)
    buffer_load_dwordx4 v[180:183], v5, s[40:43], s48 offen offset:128 nt
    s_waitcnt vmcnt(7)
    buffer_load_dwordx4 v[184:187], v5, s[40:43], s48 offen offset:256 nt
    s_waitcnt vmcnt(7)
    buffer_load_dwordx4 v[188:191], v5, s[40:43], s48 offen offset:384 nt
    v_mov_b32 v12, 0
    v_mov_b32 v13, 0
    v_mov_b32 v14, 0
    v_mov_b32 v15, 0
    v_dot2c_f32_bf16 v12, v192, v32
    v_dot2c_f32_bf16 v13, v196, v36
    v_dot2c_f32_bf16 v14, v200, v40
    v_dot2c_f32_bf16 v15, v204, v44
    v_dot2c_f32_bf16 v12, v193, v33
    v_dot2c_f32_bf16 v13, v197, v37
    v_dot2c_f32_bf16 v14, v201, v41
    v_dot2c_f32_bf16 v15, v205, v45
    v_dot2c_f32_bf16 v12, v194, v34
    v_dot2c_f32_bf16 v13, v198, v38
    v_dot2c_f32_bf16 v14, v202, v42
    v_dot2c_f32_bf16 v15, v206, v46
    v_dot2c_f32_bf16 v12, v195, v35
    v_dot2c_f32_bf16 v13, v199, v39
    v_dot2c_f32_bf16 v14, v203, v43
    v_dot2c_f32_bf16 v15, v207, v47
    s_nop 0
    v_add_f32 v12, v12, v13
    s_nop 0
    v_add_f32 v14, v14, v15
    v_add_f32 v12, v12, v14
    s_nop 1
    v_add_f32_dpp v12, v12, v12 quad_perm:[1,0,3,2] row_mask:0xf bank_mask:0xf
    s_nop 1
    v_add_f32_dpp v12, v12, v12 quad_perm:[2,3,0,1] row_mask:0xf bank_mask:0xf
    s_nop 1
    v_add_f32_dpp v12, v12, v12 row_half_mirror row_mask:0xf bank_mask:0xf
    v_cndmask_b32 v17, v17, v12, s[66:67]
    s_mov_b32 s48, 360448
    s_waitcnt vmcnt(7)
    buffer_load_dwordx4 v[192:195], v5, s[40:43], s48 offen offset:0 nt
    s_waitcnt vmcnt(7)
    buffer_load_dwordx4 v[196:199], v5, s[40:43], s48 offen offset:128 nt
    s_waitcnt vmcnt(7)
    buffer_load_dwordx4 v[200:203], v5, s[40:43], s48 offen offset:256 nt
    s_waitcnt vmcnt(7)
    buffer_load_dwordx4 v[204:207], v5, s[40:43], s48 offen offset:384 nt
    v_mov_b32 v12, 0
    v_mov_b32 v13, 0
    v_mov_b32 v14, 0
    v_mov_b32 v15, 0
    v_dot2c_f32_bf16 v12, v208, v32
    v_dot2c_f32_bf16 v13, v212, v36
    v_dot2c_f32_bf16 v14, v216, v40
    v_dot2c_f32_bf16 v15, v220, v44
    v_dot2c_f32_bf16 v12, v209, v33
    v_dot2c_f32_bf16 v13, v213, v37
    v_dot2c_f32_bf16 v14, v217, v41
    v_dot2c_f32_bf16 v15, v221, v45
    v_dot2c_f32_bf16 v12, v210, v34
    v_dot2c_f32_bf16 v13, v214, v38
    v_dot2c_f32_bf16 v14, v218, v42
    v_dot2c_f32_bf16 v15, v222, v46
    v_dot2c_f32_bf16 v12, v211, v35
    v_dot2c_f32_bf16 v13, v215, v39
    v_dot2c_f32_bf16 v14, v219, v43
    v_dot2c_f32_bf16 v15, v223, v47
    s_nop 0
    v_add_f32 v12, v12, v13
    s_nop 0
    v_add_f32 v14, v14, v15
    v_add_f32 v12, v12, v14
    s_nop 1
    v_add_f32_dpp v12, v12, v12 quad_perm:[1,0,3,2] row_mask:0xf bank_mask:0xf
    s_nop 1
    v_add_f32_dpp v12, v12, v12 quad_perm:[2,3,0,1] row_mask:0xf bank_mask:0xf
    s_nop 1
    v_add_f32_dpp v12, v12, v12 row_half_mirror row_mask:0xf bank_mask:0xf
    v_cndmask_b32 v17, v17, v12, s[68:69]
    s_mov_b32 s48, 376832
    s_waitcnt vmcnt(7)
    buffer_load_dwordx4 v[208:211], v5, s[40:43], s48 offen offset:0 nt
    s_waitcnt vmcnt(7)
    buffer_load_dwordx4 v[212:215], v5, s[40:43], s48 offen offset:128 nt
    s_waitcnt vmcnt(7)
    buffer_load_dwordx4 v[216:219], v5, s[40:43], s48 offen offset:256 nt
    s_waitcnt vmcnt(7)
    buffer_load_dwordx4 v[220:223], v5, s[40:43], s48 offen offset:384 nt
    v_mov_b32 v12, 0
    v_mov_b32 v13, 0
    v_mov_b32 v14, 0
    v_mov_b32 v15, 0
    v_dot2c_f32_bf16 v12, v224, v32
    v_dot2c_f32_bf16 v13, v228, v36
    v_dot2c_f32_bf16 v14, v232, v40
    v_dot2c_f32_bf16 v15, v236, v44
    v_dot2c_f32_bf16 v12, v225, v33
    v_dot2c_f32_bf16 v13, v229, v37
    v_dot2c_f32_bf16 v14, v233, v41
    v_dot2c_f32_bf16 v15, v237, v45
    v_dot2c_f32_bf16 v12, v226, v34
    v_dot2c_f32_bf16 v13, v230, v38
    v_dot2c_f32_bf16 v14, v234, v42
    v_dot2c_f32_bf16 v15, v238, v46
    v_dot2c_f32_bf16 v12, v227, v35
    v_dot2c_f32_bf16 v13, v231, v39
    v_dot2c_f32_bf16 v14, v235, v43
    v_dot2c_f32_bf16 v15, v239, v47
    s_nop 0
    v_add_f32 v12, v12, v13
    s_nop 0
    v_add_f32 v14, v14, v15
    v_add_f32 v12, v12, v14
    s_nop 1
    v_add_f32_dpp v12, v12, v12 quad_perm:[1,0,3,2] row_mask:0xf bank_mask:0xf
    s_nop 1
    v_add_f32_dpp v12, v12, v12 quad_perm:[2,3,0,1] row_mask:0xf bank_mask:0xf
    s_nop 1
    v_add_f32_dpp v12, v12, v12 row_half_mirror row_mask:0xf bank_mask:0xf
    v_cndmask_b32 v17, v17, v12, s[70:71]
    s_mov_b32 s48, 393216
    s_waitcnt vmcnt(7)
    buffer_load_dwordx4 v[224:227], v5, s[40:43], s48 offen offset:0 nt
    s_waitcnt vmcnt(7)
    buffer_load_dwordx4 v[228:231], v5, s[40:43], s48 offen offset:128 nt
    s_waitcnt vmcnt(7)
    buffer_load_dwordx4 v[232:235], v5, s[40:43], s48 offen offset:256 nt
    s_waitcnt vmcnt(7)
    buffer_load_dwordx4 v[236:239], v5, s[40:43], s48 offen offset:384 nt
    v_mov_b32 v12, 0
    v_mov_b32 v13, 0
    v_mov_b32 v14, 0
    v_mov_b32 v15, 0
    v_dot2c_f32_bf16 v12, v240, v32
    v_dot2c_f32_bf16 v13, v244, v36
    v_dot2c_f32_bf16 v14, v248, v40
    v_dot2c_f32_bf16 v15, v252, v44
    v_dot2c_f32_bf16 v12, v241, v33
    v_dot2c_f32_bf16 v13, v245, v37
    v_dot2c_f32_bf16 v14, v249, v41
    v_dot2c_f32_bf16 v15, v253, v45
    v_dot2c_f32_bf16 v12, v242, v34
    v_dot2c_f32_bf16 v13, v246, v38
    v_dot2c_f32_bf16 v14, v250, v42
    v_dot2c_f32_bf16 v15, v254, v46
    v_dot2c_f32_bf16 v12, v243, v35
    v_dot2c_f32_bf16 v13, v247, v39
    v_dot2c_f32_bf16 v14, v251, v43
    v_dot2c_f32_bf16 v15, v255, v47
    s_nop 0
    v_add_f32 v12, v12, v13
    s_nop 0
    v_add_f32 v14, v14, v15
    v_add_f32 v12, v12, v14
    s_nop 1
    v_add_f32_dpp v12, v12, v12 quad_perm:[1,0,3,2] row_mask:0xf bank_mask:0xf
    s_nop 1
    v_add_f32_dpp v12, v12, v12 quad_perm:[2,3,0,1] row_mask:0xf bank_mask:0xf
    s_nop 1
    v_add_f32_dpp v12, v12, v12 row_half_mirror row_mask:0xf bank_mask:0xf
    v_cndmask_b32 v17, v17, v12, s[72:73]
    s_mov_b32 s48, 409600
    s_waitcnt vmcnt(7)
    buffer_load_dwordx4 v[240:243], v5, s[40:43], s48 offen offset:0 nt
    s_waitcnt vmcnt(7)
    buffer_load_dwordx4 v[244:247], v5, s[40:43], s48 offen offset:128 nt
    s_waitcnt vmcnt(7)
    buffer_load_dwordx4 v[248:251], v5, s[40:43], s48 offen offset:256 nt
    s_waitcnt vmcnt(7)
    buffer_load_dwordx4 v[252:255], v5, s[40:43], s48 offen offset:384 nt
    v_mov_b32 v12, 0
    v_mov_b32 v13, 0
    v_mov_b32 v14, 0
    v_mov_b32 v15, 0
    v_dot2c_f32_bf16 v12, v48, v32
    v_dot2c_f32_bf16 v13, v52, v36
    v_dot2c_f32_bf16 v14, v56, v40
    v_dot2c_f32_bf16 v15, v60, v44
    v_dot2c_f32_bf16 v12, v49, v33
    v_dot2c_f32_bf16 v13, v53, v37
    v_dot2c_f32_bf16 v14, v57, v41
    v_dot2c_f32_bf16 v15, v61, v45
    v_dot2c_f32_bf16 v12, v50, v34
    v_dot2c_f32_bf16 v13, v54, v38
    v_dot2c_f32_bf16 v14, v58, v42
    v_dot2c_f32_bf16 v15, v62, v46
    v_dot2c_f32_bf16 v12, v51, v35
    v_dot2c_f32_bf16 v13, v55, v39
    v_dot2c_f32_bf16 v14, v59, v43
    v_dot2c_f32_bf16 v15, v63, v47
    s_nop 0
    v_add_f32 v12, v12, v13
    s_nop 0
    v_add_f32 v14, v14, v15
    v_add_f32 v12, v12, v14
    s_nop 1
    v_add_f32_dpp v12, v12, v12 quad_perm:[1,0,3,2] row_mask:0xf bank_mask:0xf
    s_nop 1
    v_add_f32_dpp v12, v12, v12 quad_perm:[2,3,0,1] row_mask:0xf bank_mask:0xf
    s_nop 1
    v_add_f32_dpp v12, v12, v12 row_half_mirror row_mask:0xf bank_mask:0xf
    v_cndmask_b32 v17, v17, v12, s[74:75]
    s_mov_b32 s48, 425984
    s_waitcnt vmcnt(7)
    buffer_load_dwordx4 v[48:51], v5, s[40:43], s48 offen offset:0 nt
    s_waitcnt vmcnt(7)
    buffer_load_dwordx4 v[52:55], v5, s[40:43], s48 offen offset:128 nt
    s_waitcnt vmcnt(7)
    buffer_load_dwordx4 v[56:59], v5, s[40:43], s48 offen offset:256 nt
    s_waitcnt vmcnt(7)
    buffer_load_dwordx4 v[60:63], v5, s[40:43], s48 offen offset:384 nt
    v_mov_b32 v12, 0
    v_mov_b32 v13, 0
    v_mov_b32 v14, 0
    v_mov_b32 v15, 0
    v_dot2c_f32_bf16 v12, v64, v32
    v_dot2c_f32_bf16 v13, v68, v36
    v_dot2c_f32_bf16 v14, v72, v40
    v_dot2c_f32_bf16 v15, v76, v44
    v_dot2c_f32_bf16 v12, v65, v33
    v_dot2c_f32_bf16 v13, v69, v37
    v_dot2c_f32_bf16 v14, v73, v41
    v_dot2c_f32_bf16 v15, v77, v45
    v_dot2c_f32_bf16 v12, v66, v34
    v_dot2c_f32_bf16 v13, v70, v38
    v_dot2c_f32_bf16 v14, v74, v42
    v_dot2c_f32_bf16 v15, v78, v46
    v_dot2c_f32_bf16 v12, v67, v35
    v_dot2c_f32_bf16 v13, v71, v39
    v_dot2c_f32_bf16 v14, v75, v43
    v_dot2c_f32_bf16 v15, v79, v47
    s_nop 0
    v_add_f32 v12, v12, v13
    s_nop 0
    v_add_f32 v14, v14, v15
    v_add_f32 v12, v12, v14
    s_nop 1
    v_add_f32_dpp v12, v12, v12 quad_perm:[1,0,3,2] row_mask:0xf bank_mask:0xf
    s_nop 1
    v_add_f32_dpp v12, v12, v12 quad_perm:[2,3,0,1] row_mask:0xf bank_mask:0xf
    s_nop 1
    v_add_f32_dpp v12, v12, v12 row_half_mirror row_mask:0xf bank_mask:0xf
    v_cndmask_b32 v17, v17, v12, s[76:77]
    s_mov_b32 s48, 442368
    s_waitcnt vmcnt(7)
    buffer_load_dwordx4 v[64:67], v5, s[40:43], s48 offen offset:0 nt
    s_waitcnt vmcnt(7)
    buffer_load_dwordx4 v[68:71], v5, s[40:43], s48 offen offset:128 nt
    s_waitcnt vmcnt(7)
    buffer_load_dwordx4 v[72:75], v5, s[40:43], s48 offen offset:256 nt
    s_waitcnt vmcnt(7)
    buffer_load_dwordx4 v[76:79], v5, s[40:43], s48 offen offset:384 nt
    v_mov_b32 v12, 0
    v_mov_b32 v13, 0
    v_mov_b32 v14, 0
    v_mov_b32 v15, 0
    v_dot2c_f32_bf16 v12, v80, v32
    v_dot2c_f32_bf16 v13, v84, v36
    v_dot2c_f32_bf16 v14, v88, v40
    v_dot2c_f32_bf16 v15, v92, v44
    v_dot2c_f32_bf16 v12, v81, v33
    v_dot2c_f32_bf16 v13, v85, v37
    v_dot2c_f32_bf16 v14, v89, v41
    v_dot2c_f32_bf16 v15, v93, v45
    v_dot2c_f32_bf16 v12, v82, v34
    v_dot2c_f32_bf16 v13, v86, v38
    v_dot2c_f32_bf16 v14, v90, v42
    v_dot2c_f32_bf16 v15, v94, v46
    v_dot2c_f32_bf16 v12, v83, v35
    v_dot2c_f32_bf16 v13, v87, v39
    v_dot2c_f32_bf16 v14, v91, v43
    v_dot2c_f32_bf16 v15, v95, v47
    s_nop 0
    v_add_f32 v12, v12, v13
    s_nop 0
    v_add_f32 v14, v14, v15
    v_add_f32 v12, v12, v14
    s_nop 1
    v_add_f32_dpp v12, v12, v12 quad_perm:[1,0,3,2] row_mask:0xf bank_mask:0xf
    s_nop 1
    v_add_f32_dpp v12, v12, v12 quad_perm:[2,3,0,1] row_mask:0xf bank_mask:0xf
    s_nop 1
    v_add_f32_dpp v12, v12, v12 row_half_mirror row_mask:0xf bank_mask:0xf
    v_cndmask_b32 v17, v17, v12, s[78:79]
    v_cvt_pk_bf16_f32 v18, v16, v17
    v_min_u32 v18, -2, v18
    buffer_store_dword v18, v10, s[12:15], s49 offen offset:0 sc1
    s_mov_b32 s48, 458752
    s_waitcnt vmcnt(7)
    buffer_load_dwordx4 v[80:83], v5, s[40:43], s48 offen offset:0 nt
    s_waitcnt vmcnt(7)
    buffer_load_dwordx4 v[84:87], v5, s[40:43], s48 offen offset:128 nt
    s_waitcnt vmcnt(7)
    buffer_load_dwordx4 v[88:91], v5, s[40:43], s48 offen offset:256 nt
    s_waitcnt vmcnt(7)
    buffer_load_dwordx4 v[92:95], v5, s[40:43], s48 offen offset:384 nt
    v_mov_b32 v12, 0
    v_mov_b32 v13, 0
    v_mov_b32 v14, 0
    v_mov_b32 v15, 0
    v_dot2c_f32_bf16 v12, v96, v32
    v_dot2c_f32_bf16 v13, v100, v36
    v_dot2c_f32_bf16 v14, v104, v40
    v_dot2c_f32_bf16 v15, v108, v44
    v_dot2c_f32_bf16 v12, v97, v33
    v_dot2c_f32_bf16 v13, v101, v37
    v_dot2c_f32_bf16 v14, v105, v41
    v_dot2c_f32_bf16 v15, v109, v45
    v_dot2c_f32_bf16 v12, v98, v34
    v_dot2c_f32_bf16 v13, v102, v38
    v_dot2c_f32_bf16 v14, v106, v42
    v_dot2c_f32_bf16 v15, v110, v46
    v_dot2c_f32_bf16 v12, v99, v35
    v_dot2c_f32_bf16 v13, v103, v39
    v_dot2c_f32_bf16 v14, v107, v43
    v_dot2c_f32_bf16 v15, v111, v47
    s_nop 0
    v_add_f32 v12, v12, v13
    s_nop 0
    v_add_f32 v14, v14, v15
    v_add_f32 v12, v12, v14
    s_nop 1
    v_add_f32_dpp v12, v12, v12 quad_perm:[1,0,3,2] row_mask:0xf bank_mask:0xf
    s_nop 1
    v_add_f32_dpp v12, v12, v12 quad_perm:[2,3,0,1] row_mask:0xf bank_mask:0xf
    s_nop 1
    v_add_f32_dpp v12, v12, v12 row_half_mirror row_mask:0xf bank_mask:0xf
    v_cndmask_b32 v16, v16, v12, s[64:65]
    s_mov_b32 s48, 475136
    s_waitcnt vmcnt(7)
    buffer_load_dwordx4 v[96:99], v5, s[40:43], s48 offen offset:0 nt
    s_waitcnt vmcnt(7)
    buffer_load_dwordx4 v[100:103], v5, s[40:43], s48 offen offset:128 nt
    s_waitcnt vmcnt(7)
    buffer_load_dwordx4 v[104:107], v5, s[40:43], s48 offen offset:256 nt
    s_waitcnt vmcnt(7)
    buffer_load_dwordx4 v[108:111], v5, s[40:43], s48 offen offset:384 nt
    v_mov_b32 v12, 0
    v_mov_b32 v13, 0
    v_mov_b32 v14, 0
    v_mov_b32 v15, 0
    v_dot2c_f32_bf16 v12, v112, v32
    v_dot2c_f32_bf16 v13, v116, v36
    v_dot2c_f32_bf16 v14, v120, v40
    v_dot2c_f32_bf16 v15, v124, v44
    v_dot2c_f32_bf16 v12, v113, v33
    v_dot2c_f32_bf16 v13, v117, v37
    v_dot2c_f32_bf16 v14, v121, v41
    v_dot2c_f32_bf16 v15, v125, v45
    v_dot2c_f32_bf16 v12, v114, v34
    v_dot2c_f32_bf16 v13, v118, v38
    v_dot2c_f32_bf16 v14, v122, v42
    v_dot2c_f32_bf16 v15, v126, v46
    v_dot2c_f32_bf16 v12, v115, v35
    v_dot2c_f32_bf16 v13, v119, v39
    v_dot2c_f32_bf16 v14, v123, v43
    v_dot2c_f32_bf16 v15, v127, v47
    s_nop 0
    v_add_f32 v12, v12, v13
    s_nop 0
    v_add_f32 v14, v14, v15
    v_add_f32 v12, v12, v14
    s_nop 1
    v_add_f32_dpp v12, v12, v12 quad_perm:[1,0,3,2] row_mask:0xf bank_mask:0xf
    s_nop 1
    v_add_f32_dpp v12, v12, v12 quad_perm:[2,3,0,1] row_mask:0xf bank_mask:0xf
    s_nop 1
    v_add_f32_dpp v12, v12, v12 row_half_mirror row_mask:0xf bank_mask:0xf
    v_cndmask_b32 v16, v16, v12, s[66:67]
    s_mov_b32 s48, 491520
    s_waitcnt vmcnt(7)
    buffer_load_dwordx4 v[112:115], v5, s[40:43], s48 offen offset:0 nt
    s_waitcnt vmcnt(7)
    buffer_load_dwordx4 v[116:119], v5, s[40:43], s48 offen offset:128 nt
    s_waitcnt vmcnt(7)
    buffer_load_dwordx4 v[120:123], v5, s[40:43], s48 offen offset:256 nt
    s_waitcnt vmcnt(7)
    buffer_load_dwordx4 v[124:127], v5, s[40:43], s48 offen offset:384 nt
    v_mov_b32 v12, 0
    v_mov_b32 v13, 0
    v_mov_b32 v14, 0
    v_mov_b32 v15, 0
    v_dot2c_f32_bf16 v12, v128, v32
    v_dot2c_f32_bf16 v13, v132, v36
    v_dot2c_f32_bf16 v14, v136, v40
    v_dot2c_f32_bf16 v15, v140, v44
    v_dot2c_f32_bf16 v12, v129, v33
    v_dot2c_f32_bf16 v13, v133, v37
    v_dot2c_f32_bf16 v14, v137, v41
    v_dot2c_f32_bf16 v15, v141, v45
    v_dot2c_f32_bf16 v12, v130, v34
    v_dot2c_f32_bf16 v13, v134, v38
    v_dot2c_f32_bf16 v14, v138, v42
    v_dot2c_f32_bf16 v15, v142, v46
    v_dot2c_f32_bf16 v12, v131, v35
    v_dot2c_f32_bf16 v13, v135, v39
    v_dot2c_f32_bf16 v14, v139, v43
    v_dot2c_f32_bf16 v15, v143, v47
    s_nop 0
    v_add_f32 v12, v12, v13
    s_nop 0
    v_add_f32 v14, v14, v15
    v_add_f32 v12, v12, v14
    s_nop 1
    v_add_f32_dpp v12, v12, v12 quad_perm:[1,0,3,2] row_mask:0xf bank_mask:0xf
    s_nop 1
    v_add_f32_dpp v12, v12, v12 quad_perm:[2,3,0,1] row_mask:0xf bank_mask:0xf
    s_nop 1
    v_add_f32_dpp v12, v12, v12 row_half_mirror row_mask:0xf bank_mask:0xf
    v_cndmask_b32 v16, v16, v12, s[68:69]
    s_mov_b32 s48, 507904
    s_waitcnt vmcnt(7)
    buffer_load_dwordx4 v[128:131], v5, s[40:43], s48 offen offset:0 nt
    s_waitcnt vmcnt(7)
    buffer_load_dwordx4 v[132:135], v5, s[40:43], s48 offen offset:128 nt
    s_waitcnt vmcnt(7)
    buffer_load_dwordx4 v[136:139], v5, s[40:43], s48 offen offset:256 nt
    s_waitcnt vmcnt(7)
    buffer_load_dwordx4 v[140:143], v5, s[40:43], s48 offen offset:384 nt
    v_mov_b32 v12, 0
    v_mov_b32 v13, 0
    v_mov_b32 v14, 0
    v_mov_b32 v15, 0
    v_dot2c_f32_bf16 v12, v144, v32
    v_dot2c_f32_bf16 v13, v148, v36
    v_dot2c_f32_bf16 v14, v152, v40
    v_dot2c_f32_bf16 v15, v156, v44
    v_dot2c_f32_bf16 v12, v145, v33
    v_dot2c_f32_bf16 v13, v149, v37
    v_dot2c_f32_bf16 v14, v153, v41
    v_dot2c_f32_bf16 v15, v157, v45
    v_dot2c_f32_bf16 v12, v146, v34
    v_dot2c_f32_bf16 v13, v150, v38
    v_dot2c_f32_bf16 v14, v154, v42
    v_dot2c_f32_bf16 v15, v158, v46
    v_dot2c_f32_bf16 v12, v147, v35
    v_dot2c_f32_bf16 v13, v151, v39
    v_dot2c_f32_bf16 v14, v155, v43
    v_dot2c_f32_bf16 v15, v159, v47
    s_nop 0
    v_add_f32 v12, v12, v13
    s_nop 0
    v_add_f32 v14, v14, v15
    v_add_f32 v12, v12, v14
    s_nop 1
    v_add_f32_dpp v12, v12, v12 quad_perm:[1,0,3,2] row_mask:0xf bank_mask:0xf
    s_nop 1
    v_add_f32_dpp v12, v12, v12 quad_perm:[2,3,0,1] row_mask:0xf bank_mask:0xf
    s_nop 1
    v_add_f32_dpp v12, v12, v12 row_half_mirror row_mask:0xf bank_mask:0xf
    v_cndmask_b32 v16, v16, v12, s[70:71]
    v_mov_b32 v12, 0
    v_mov_b32 v13, 0
    v_mov_b32 v14, 0
    v_mov_b32 v15, 0
    v_dot2c_f32_bf16 v12, v160, v32
    v_dot2c_f32_bf16 v13, v164, v36
    v_dot2c_f32_bf16 v14, v168, v40
    v_dot2c_f32_bf16 v15, v172, v44
    v_dot2c_f32_bf16 v12, v161, v33
    v_dot2c_f32_bf16 v13, v165, v37
    v_dot2c_f32_bf16 v14, v169, v41
    v_dot2c_f32_bf16 v15, v173, v45
    v_dot2c_f32_bf16 v12, v162, v34
    v_dot2c_f32_bf16 v13, v166, v38
    v_dot2c_f32_bf16 v14, v170, v42
    v_dot2c_f32_bf16 v15, v174, v46
    v_dot2c_f32_bf16 v12, v163, v35
    v_dot2c_f32_bf16 v13, v167, v39
    v_dot2c_f32_bf16 v14, v171, v43
    v_dot2c_f32_bf16 v15, v175, v47
    s_nop 0
    v_add_f32 v12, v12, v13
    s_nop 0
    v_add_f32 v14, v14, v15
    v_add_f32 v12, v12, v14
    s_nop 1
    v_add_f32_dpp v12, v12, v12 quad_perm:[1,0,3,2] row_mask:0xf bank_mask:0xf
    s_nop 1
    v_add_f32_dpp v12, v12, v12 quad_perm:[2,3,0,1] row_mask:0xf bank_mask:0xf
    s_nop 1
    v_add_f32_dpp v12, v12, v12 row_half_mirror row_mask:0xf bank_mask:0xf
    v_cndmask_b32 v16, v16, v12, s[72:73]
    v_mov_b32 v12, 0
    v_mov_b32 v13, 0
    v_mov_b32 v14, 0
    v_mov_b32 v15, 0
    v_dot2c_f32_bf16 v12, v176, v32
    v_dot2c_f32_bf16 v13, v180, v36
    v_dot2c_f32_bf16 v14, v184, v40
    v_dot2c_f32_bf16 v15, v188, v44
    v_dot2c_f32_bf16 v12, v177, v33
    v_dot2c_f32_bf16 v13, v181, v37
    v_dot2c_f32_bf16 v14, v185, v41
    v_dot2c_f32_bf16 v15, v189, v45
    v_dot2c_f32_bf16 v12, v178, v34
    v_dot2c_f32_bf16 v13, v182, v38
    v_dot2c_f32_bf16 v14, v186, v42
    v_dot2c_f32_bf16 v15, v190, v46
    v_dot2c_f32_bf16 v12, v179, v35
    v_dot2c_f32_bf16 v13, v183, v39
    v_dot2c_f32_bf16 v14, v187, v43
    v_dot2c_f32_bf16 v15, v191, v47
    s_nop 0
    v_add_f32 v12, v12, v13
    s_nop 0
    v_add_f32 v14, v14, v15
    v_add_f32 v12, v12, v14
    s_nop 1
    v_add_f32_dpp v12, v12, v12 quad_perm:[1,0,3,2] row_mask:0xf bank_mask:0xf
    s_nop 1
    v_add_f32_dpp v12, v12, v12 quad_perm:[2,3,0,1] row_mask:0xf bank_mask:0xf
    s_nop 1
    v_add_f32_dpp v12, v12, v12 row_half_mirror row_mask:0xf bank_mask:0xf
    v_cndmask_b32 v16, v16, v12, s[74:75]
    v_mov_b32 v12, 0
    v_mov_b32 v13, 0
    v_mov_b32 v14, 0
    v_mov_b32 v15, 0
    v_dot2c_f32_bf16 v12, v192, v32
    v_dot2c_f32_bf16 v13, v196, v36
    v_dot2c_f32_bf16 v14, v200, v40
    v_dot2c_f32_bf16 v15, v204, v44
    v_dot2c_f32_bf16 v12, v193, v33
    v_dot2c_f32_bf16 v13, v197, v37
    v_dot2c_f32_bf16 v14, v201, v41
    v_dot2c_f32_bf16 v15, v205, v45
    v_dot2c_f32_bf16 v12, v194, v34
    v_dot2c_f32_bf16 v13, v198, v38
    v_dot2c_f32_bf16 v14, v202, v42
    v_dot2c_f32_bf16 v15, v206, v46
    v_dot2c_f32_bf16 v12, v195, v35
    v_dot2c_f32_bf16 v13, v199, v39
    v_dot2c_f32_bf16 v14, v203, v43
    v_dot2c_f32_bf16 v15, v207, v47
    s_nop 0
    v_add_f32 v12, v12, v13
    s_nop 0
    v_add_f32 v14, v14, v15
    v_add_f32 v12, v12, v14
    s_nop 1
    v_add_f32_dpp v12, v12, v12 quad_perm:[1,0,3,2] row_mask:0xf bank_mask:0xf
    s_nop 1
    v_add_f32_dpp v12, v12, v12 quad_perm:[2,3,0,1] row_mask:0xf bank_mask:0xf
    s_nop 1
    v_add_f32_dpp v12, v12, v12 row_half_mirror row_mask:0xf bank_mask:0xf
    v_cndmask_b32 v16, v16, v12, s[76:77]
    v_mov_b32 v12, 0
    v_mov_b32 v13, 0
    v_mov_b32 v14, 0
    v_mov_b32 v15, 0
    v_dot2c_f32_bf16 v12, v208, v32
    v_dot2c_f32_bf16 v13, v212, v36
    v_dot2c_f32_bf16 v14, v216, v40
    v_dot2c_f32_bf16 v15, v220, v44
    v_dot2c_f32_bf16 v12, v209, v33
    v_dot2c_f32_bf16 v13, v213, v37
    v_dot2c_f32_bf16 v14, v217, v41
    v_dot2c_f32_bf16 v15, v221, v45
    v_dot2c_f32_bf16 v12, v210, v34
    v_dot2c_f32_bf16 v13, v214, v38
    v_dot2c_f32_bf16 v14, v218, v42
    v_dot2c_f32_bf16 v15, v222, v46
    v_dot2c_f32_bf16 v12, v211, v35
    v_dot2c_f32_bf16 v13, v215, v39
    v_dot2c_f32_bf16 v14, v219, v43
    v_dot2c_f32_bf16 v15, v223, v47
    s_nop 0
    v_add_f32 v12, v12, v13
    s_nop 0
    v_add_f32 v14, v14, v15
    v_add_f32 v12, v12, v14
    s_nop 1
    v_add_f32_dpp v12, v12, v12 quad_perm:[1,0,3,2] row_mask:0xf bank_mask:0xf
    s_nop 1
    v_add_f32_dpp v12, v12, v12 quad_perm:[2,3,0,1] row_mask:0xf bank_mask:0xf
    s_nop 1
    v_add_f32_dpp v12, v12, v12 row_half_mirror row_mask:0xf bank_mask:0xf
    v_cndmask_b32 v16, v16, v12, s[78:79]
    v_mov_b32 v12, 0
    v_mov_b32 v13, 0
    v_mov_b32 v14, 0
    v_mov_b32 v15, 0
    v_dot2c_f32_bf16 v12, v224, v32
    v_dot2c_f32_bf16 v13, v228, v36
    v_dot2c_f32_bf16 v14, v232, v40
    v_dot2c_f32_bf16 v15, v236, v44
    v_dot2c_f32_bf16 v12, v225, v33
    v_dot2c_f32_bf16 v13, v229, v37
    v_dot2c_f32_bf16 v14, v233, v41
    v_dot2c_f32_bf16 v15, v237, v45
    v_dot2c_f32_bf16 v12, v226, v34
    v_dot2c_f32_bf16 v13, v230, v38
    v_dot2c_f32_bf16 v14, v234, v42
    v_dot2c_f32_bf16 v15, v238, v46
    v_dot2c_f32_bf16 v12, v227, v35
    v_dot2c_f32_bf16 v13, v231, v39
    v_dot2c_f32_bf16 v14, v235, v43
    v_dot2c_f32_bf16 v15, v239, v47
    s_nop 0
    v_add_f32 v12, v12, v13
    s_nop 0
    v_add_f32 v14, v14, v15
    v_add_f32 v12, v12, v14
    s_nop 1
    v_add_f32_dpp v12, v12, v12 quad_perm:[1,0,3,2] row_mask:0xf bank_mask:0xf
    s_nop 1
    v_add_f32_dpp v12, v12, v12 quad_perm:[2,3,0,1] row_mask:0xf bank_mask:0xf
    s_nop 1
    v_add_f32_dpp v12, v12, v12 row_half_mirror row_mask:0xf bank_mask:0xf
    v_cndmask_b32 v17, v17, v12, s[64:65]
    v_mov_b32 v12, 0
    v_mov_b32 v13, 0
    v_mov_b32 v14, 0
    v_mov_b32 v15, 0
    v_dot2c_f32_bf16 v12, v240, v32
    v_dot2c_f32_bf16 v13, v244, v36
    v_dot2c_f32_bf16 v14, v248, v40
    v_dot2c_f32_bf16 v15, v252, v44
    v_dot2c_f32_bf16 v12, v241, v33
    v_dot2c_f32_bf16 v13, v245, v37
    v_dot2c_f32_bf16 v14, v249, v41
    v_dot2c_f32_bf16 v15, v253, v45
    v_dot2c_f32_bf16 v12, v242, v34
    v_dot2c_f32_bf16 v13, v246, v38
    v_dot2c_f32_bf16 v14, v250, v42
    v_dot2c_f32_bf16 v15, v254, v46
    v_dot2c_f32_bf16 v12, v243, v35
    v_dot2c_f32_bf16 v13, v247, v39
    v_dot2c_f32_bf16 v14, v251, v43
    v_dot2c_f32_bf16 v15, v255, v47
    s_nop 0
    v_add_f32 v12, v12, v13
    s_nop 0
    v_add_f32 v14, v14, v15
    v_add_f32 v12, v12, v14
    s_nop 1
    v_add_f32_dpp v12, v12, v12 quad_perm:[1,0,3,2] row_mask:0xf bank_mask:0xf
    s_nop 1
    v_add_f32_dpp v12, v12, v12 quad_perm:[2,3,0,1] row_mask:0xf bank_mask:0xf
    s_nop 1
    v_add_f32_dpp v12, v12, v12 row_half_mirror row_mask:0xf bank_mask:0xf
    v_cndmask_b32 v17, v17, v12, s[66:67]
    v_mov_b32 v12, 0
    v_mov_b32 v13, 0
    v_mov_b32 v14, 0
    v_mov_b32 v15, 0
    v_dot2c_f32_bf16 v12, v48, v32
    v_dot2c_f32_bf16 v13, v52, v36
    v_dot2c_f32_bf16 v14, v56, v40
    v_dot2c_f32_bf16 v15, v60, v44
    v_dot2c_f32_bf16 v12, v49, v33
    v_dot2c_f32_bf16 v13, v53, v37
    v_dot2c_f32_bf16 v14, v57, v41
    v_dot2c_f32_bf16 v15, v61, v45
    v_dot2c_f32_bf16 v12, v50, v34
    v_dot2c_f32_bf16 v13, v54, v38
    v_dot2c_f32_bf16 v14, v58, v42
    v_dot2c_f32_bf16 v15, v62, v46
    v_dot2c_f32_bf16 v12, v51, v35
    v_dot2c_f32_bf16 v13, v55, v39
    v_dot2c_f32_bf16 v14, v59, v43
    v_dot2c_f32_bf16 v15, v63, v47
    s_nop 0
    v_add_f32 v12, v12, v13
    s_nop 0
    v_add_f32 v14, v14, v15
    v_add_f32 v12, v12, v14
    s_nop 1
    v_add_f32_dpp v12, v12, v12 quad_perm:[1,0,3,2] row_mask:0xf bank_mask:0xf
    s_nop 1
    v_add_f32_dpp v12, v12, v12 quad_perm:[2,3,0,1] row_mask:0xf bank_mask:0xf
    s_nop 1
    v_add_f32_dpp v12, v12, v12 row_half_mirror row_mask:0xf bank_mask:0xf
    v_cndmask_b32 v17, v17, v12, s[68:69]
    v_mov_b32 v12, 0
    v_mov_b32 v13, 0
    v_mov_b32 v14, 0
    v_mov_b32 v15, 0
    v_dot2c_f32_bf16 v12, v64, v32
    v_dot2c_f32_bf16 v13, v68, v36
    v_dot2c_f32_bf16 v14, v72, v40
    v_dot2c_f32_bf16 v15, v76, v44
    v_dot2c_f32_bf16 v12, v65, v33
    v_dot2c_f32_bf16 v13, v69, v37
    v_dot2c_f32_bf16 v14, v73, v41
    v_dot2c_f32_bf16 v15, v77, v45
    v_dot2c_f32_bf16 v12, v66, v34
    v_dot2c_f32_bf16 v13, v70, v38
    v_dot2c_f32_bf16 v14, v74, v42
    v_dot2c_f32_bf16 v15, v78, v46
    v_dot2c_f32_bf16 v12, v67, v35
    v_dot2c_f32_bf16 v13, v71, v39
    v_dot2c_f32_bf16 v14, v75, v43
    v_dot2c_f32_bf16 v15, v79, v47
    s_nop 0
    v_add_f32 v12, v12, v13
    s_nop 0
    v_add_f32 v14, v14, v15
    v_add_f32 v12, v12, v14
    s_nop 1
    v_add_f32_dpp v12, v12, v12 quad_perm:[1,0,3,2] row_mask:0xf bank_mask:0xf
    s_nop 1
    v_add_f32_dpp v12, v12, v12 quad_perm:[2,3,0,1] row_mask:0xf bank_mask:0xf
    s_nop 1
    v_add_f32_dpp v12, v12, v12 row_half_mirror row_mask:0xf bank_mask:0xf
    v_cndmask_b32 v17, v17, v12, s[70:71]
    v_mov_b32 v12, 0
    v_mov_b32 v13, 0
    v_mov_b32 v14, 0
    v_mov_b32 v15, 0
    v_dot2c_f32_bf16 v12, v80, v32
    v_dot2c_f32_bf16 v13, v84, v36
    v_dot2c_f32_bf16 v14, v88, v40
    v_dot2c_f32_bf16 v15, v92, v44
    v_dot2c_f32_bf16 v12, v81, v33
    v_dot2c_f32_bf16 v13, v85, v37
    v_dot2c_f32_bf16 v14, v89, v41
    v_dot2c_f32_bf16 v15, v93, v45
    v_dot2c_f32_bf16 v12, v82, v34
    v_dot2c_f32_bf16 v13, v86, v38
    v_dot2c_f32_bf16 v14, v90, v42
    v_dot2c_f32_bf16 v15, v94, v46
    v_dot2c_f32_bf16 v12, v83, v35
    v_dot2c_f32_bf16 v13, v87, v39
    v_dot2c_f32_bf16 v14, v91, v43
    v_dot2c_f32_bf16 v15, v95, v47
    s_nop 0
    v_add_f32 v12, v12, v13
    s_nop 0
    v_add_f32 v14, v14, v15
    v_add_f32 v12, v12, v14
    s_nop 1
    v_add_f32_dpp v12, v12, v12 quad_perm:[1,0,3,2] row_mask:0xf bank_mask:0xf
    s_nop 1
    v_add_f32_dpp v12, v12, v12 quad_perm:[2,3,0,1] row_mask:0xf bank_mask:0xf
    s_nop 1
    v_add_f32_dpp v12, v12, v12 row_half_mirror row_mask:0xf bank_mask:0xf
    v_cndmask_b32 v17, v17, v12, s[72:73]
    v_mov_b32 v12, 0
    v_mov_b32 v13, 0
    v_mov_b32 v14, 0
    v_mov_b32 v15, 0
    v_dot2c_f32_bf16 v12, v96, v32
    v_dot2c_f32_bf16 v13, v100, v36
    v_dot2c_f32_bf16 v14, v104, v40
    v_dot2c_f32_bf16 v15, v108, v44
    v_dot2c_f32_bf16 v12, v97, v33
    v_dot2c_f32_bf16 v13, v101, v37
    v_dot2c_f32_bf16 v14, v105, v41
    v_dot2c_f32_bf16 v15, v109, v45
    v_dot2c_f32_bf16 v12, v98, v34
    v_dot2c_f32_bf16 v13, v102, v38
    v_dot2c_f32_bf16 v14, v106, v42
    v_dot2c_f32_bf16 v15, v110, v46
    v_dot2c_f32_bf16 v12, v99, v35
    v_dot2c_f32_bf16 v13, v103, v39
    v_dot2c_f32_bf16 v14, v107, v43
    v_dot2c_f32_bf16 v15, v111, v47
    s_nop 0
    v_add_f32 v12, v12, v13
    s_nop 0
    v_add_f32 v14, v14, v15
    v_add_f32 v12, v12, v14
    s_nop 1
    v_add_f32_dpp v12, v12, v12 quad_perm:[1,0,3,2] row_mask:0xf bank_mask:0xf
    s_nop 1
    v_add_f32_dpp v12, v12, v12 quad_perm:[2,3,0,1] row_mask:0xf bank_mask:0xf
    s_nop 1
    v_add_f32_dpp v12, v12, v12 row_half_mirror row_mask:0xf bank_mask:0xf
    v_cndmask_b32 v17, v17, v12, s[74:75]
    s_mov_b32 s48, 0
    s_waitcnt vmcnt(7)
    buffer_load_dwordx4 v[144:147], v6, s[44:47], s48 offen nt
    s_waitcnt vmcnt(7)
    buffer_load_dwordx4 v[148:151], v7, s[44:47], s48 offen nt
    s_waitcnt vmcnt(7)
    buffer_load_dwordx4 v[152:155], v8, s[44:47], s48 offen nt
    s_waitcnt vmcnt(7)
    buffer_load_dwordx4 v[156:159], v9, s[44:47], s48 offen nt
    v_mov_b32 v12, 0
    v_mov_b32 v13, 0
    v_mov_b32 v14, 0
    v_mov_b32 v15, 0
    v_dot2c_f32_bf16 v12, v112, v32
    v_dot2c_f32_bf16 v13, v116, v36
    v_dot2c_f32_bf16 v14, v120, v40
    v_dot2c_f32_bf16 v15, v124, v44
    v_dot2c_f32_bf16 v12, v113, v33
    v_dot2c_f32_bf16 v13, v117, v37
    v_dot2c_f32_bf16 v14, v121, v41
    v_dot2c_f32_bf16 v15, v125, v45
    v_dot2c_f32_bf16 v12, v114, v34
    v_dot2c_f32_bf16 v13, v118, v38
    v_dot2c_f32_bf16 v14, v122, v42
    v_dot2c_f32_bf16 v15, v126, v46
    v_dot2c_f32_bf16 v12, v115, v35
    v_dot2c_f32_bf16 v13, v119, v39
    v_dot2c_f32_bf16 v14, v123, v43
    v_dot2c_f32_bf16 v15, v127, v47
    s_nop 0
    v_add_f32 v12, v12, v13
    s_nop 0
    v_add_f32 v14, v14, v15
    v_add_f32 v12, v12, v14
    s_nop 1
    v_add_f32_dpp v12, v12, v12 quad_perm:[1,0,3,2] row_mask:0xf bank_mask:0xf
    s_nop 1
    v_add_f32_dpp v12, v12, v12 quad_perm:[2,3,0,1] row_mask:0xf bank_mask:0xf
    s_nop 1
    v_add_f32_dpp v12, v12, v12 row_half_mirror row_mask:0xf bank_mask:0xf
    v_cndmask_b32 v17, v17, v12, s[76:77]
    s_mov_b32 s48, 65536
    s_waitcnt vmcnt(7)
    buffer_load_dwordx4 v[160:163], v6, s[44:47], s48 offen nt
    s_waitcnt vmcnt(7)
    buffer_load_dwordx4 v[164:167], v7, s[44:47], s48 offen nt
    s_waitcnt vmcnt(7)
    buffer_load_dwordx4 v[168:171], v8, s[44:47], s48 offen nt
    s_waitcnt vmcnt(7)
    buffer_load_dwordx4 v[172:175], v9, s[44:47], s48 offen nt
    v_mov_b32 v12, 0
    v_mov_b32 v13, 0
    v_mov_b32 v14, 0
    v_mov_b32 v15, 0
    v_dot2c_f32_bf16 v12, v128, v32
    v_dot2c_f32_bf16 v13, v132, v36
    v_dot2c_f32_bf16 v14, v136, v40
    v_dot2c_f32_bf16 v15, v140, v44
    v_dot2c_f32_bf16 v12, v129, v33
    v_dot2c_f32_bf16 v13, v133, v37
    v_dot2c_f32_bf16 v14, v137, v41
    v_dot2c_f32_bf16 v15, v141, v45
    v_dot2c_f32_bf16 v12, v130, v34
    v_dot2c_f32_bf16 v13, v134, v38
    v_dot2c_f32_bf16 v14, v138, v42
    v_dot2c_f32_bf16 v15, v142, v46
    v_dot2c_f32_bf16 v12, v131, v35
    v_dot2c_f32_bf16 v13, v135, v39
    v_dot2c_f32_bf16 v14, v139, v43
    v_dot2c_f32_bf16 v15, v143, v47
    s_nop 0
    v_add_f32 v12, v12, v13
    s_nop 0
    v_add_f32 v14, v14, v15
    v_add_f32 v12, v12, v14
    s_nop 1
    v_add_f32_dpp v12, v12, v12 quad_perm:[1,0,3,2] row_mask:0xf bank_mask:0xf
    s_nop 1
    v_add_f32_dpp v12, v12, v12 quad_perm:[2,3,0,1] row_mask:0xf bank_mask:0xf
    s_nop 1
    v_add_f32_dpp v12, v12, v12 row_half_mirror row_mask:0xf bank_mask:0xf
    v_cndmask_b32 v17, v17, v12, s[78:79]
    v_cvt_pk_bf16_f32 v18, v16, v17
    v_min_u32 v18, -2, v18
    buffer_store_dword v18, v10, s[12:15], s49 offen offset:256 sc1
    s_mov_b64 exec, 1
    v_mov_b32 v19, 16900
    v_mov_b32 v18, 1
    ds_add_u32 v19, v18
    s_mov_b64 exec, -1
    v_and_b32 v19, 1, v1
    v_cmp_eq_u32 vcc, 1, v19
    v_mov_b32 v18, 0xffff
    v_mov_b32 v19, 0xffff0000
    v_cndmask_b32 v18, v18, v19, vcc
    v_lshrrev_b32 v19, 1, v4
    v_cmp_eq_u32 vcc, 0, v19
    s_nop 1
    v_cndmask_b32 v32, 0, v18, vcc
    v_cmp_eq_u32 vcc, 1, v19
    s_nop 1
    v_cndmask_b32 v33, 0, v18, vcc
    v_cmp_eq_u32 vcc, 2, v19
    s_nop 1
    v_cndmask_b32 v34, 0, v18, vcc
    v_cmp_eq_u32 vcc, 3, v19
    s_nop 1
    v_cndmask_b32 v35, 0, v18, vcc
    v_mov_b32 v44, 0
    v_mov_b32 v45, 0
    v_mov_b32 v46, 0
    v_mov_b32 v47, 0
    v_bfe_u32 v18, v1, 4, 1
    v_lshlrev_b32 v18, 4, v18
    v_lshl_add_u32 v18, v4, 5, v18
    v_lshrrev_b32 v10, 5, v1
    v_lshl_add_u32 v10, v10, 8, v18
    s_lshl_b32 s9, s3, 9
    v_add_u32 v10, s9, v10
    s_mov_b32 s48, 131072
    s_waitcnt vmcnt(7)
    buffer_load_dwordx4 v[176:179], v6, s[44:47], s48 offen nt
    s_waitcnt vmcnt(7)
    buffer_load_dwordx4 v[180:183], v7, s[44:47], s48 offen nt
    s_waitcnt vmcnt(7)
    buffer_load_dwordx4 v[184:187], v8, s[44:47], s48 offen nt
    s_waitcnt vmcnt(7)
    buffer_load_dwordx4 v[188:191], v9, s[44:47], s48 offen nt
    s_mov_b32 s48, 196608
    s_waitcnt vmcnt(7)
    buffer_load_dwordx4 v[192:195], v6, s[44:47], s48 offen nt
    s_waitcnt vmcnt(7)
    buffer_load_dwordx4 v[196:199], v7, s[44:47], s48 offen nt
    s_waitcnt vmcnt(7)
    buffer_load_dwordx4 v[200:203], v8, s[44:47], s48 offen nt
    s_waitcnt vmcnt(7)
    buffer_load_dwordx4 v[204:207], v9, s[44:47], s48 offen nt
    s_mov_b32 s48, 262144
    s_waitcnt vmcnt(7)
    buffer_load_dwordx4 v[208:211], v6, s[44:47], s48 offen nt
    s_waitcnt vmcnt(7)
    buffer_load_dwordx4 v[212:215], v7, s[44:47], s48 offen nt
    s_waitcnt vmcnt(7)
    buffer_load_dwordx4 v[216:219], v8, s[44:47], s48 offen nt
    s_waitcnt vmcnt(7)
    buffer_load_dwordx4 v[220:223], v9, s[44:47], s48 offen nt
    s_mov_b32 s48, 327680
    s_waitcnt vmcnt(7)
    buffer_load_dwordx4 v[224:227], v6, s[44:47], s48 offen nt
    s_waitcnt vmcnt(7)
    buffer_load_dwordx4 v[228:231], v7, s[44:47], s48 offen nt
    s_waitcnt vmcnt(7)
    buffer_load_dwordx4 v[232:235], v8, s[44:47], s48 offen nt
    s_waitcnt vmcnt(7)
    buffer_load_dwordx4 v[236:239], v9, s[44:47], s48 offen nt
    s_mov_b32 s48, 393216
    s_waitcnt vmcnt(7)
    buffer_load_dwordx4 v[240:243], v6, s[44:47], s48 offen nt
    s_waitcnt vmcnt(7)
    buffer_load_dwordx4 v[244:247], v7, s[44:47], s48 offen nt
    s_waitcnt vmcnt(7)
    buffer_load_dwordx4 v[248:251], v8, s[44:47], s48 offen nt
    s_waitcnt vmcnt(7)
    buffer_load_dwordx4 v[252:255], v9, s[44:47], s48 offen nt
    s_mov_b32 s48, 458752
    s_waitcnt vmcnt(7)
    buffer_load_dwordx4 v[48:51], v6, s[44:47], s48 offen nt
    s_waitcnt vmcnt(7)
    buffer_load_dwordx4 v[52:55], v7, s[44:47], s48 offen nt
    s_waitcnt vmcnt(7)
    buffer_load_dwordx4 v[56:59], v8, s[44:47], s48 offen nt
    s_waitcnt vmcnt(7)
    buffer_load_dwordx4 v[60:63], v9, s[44:47], s48 offen nt
    s_mov_b32 s48, 524288
    s_waitcnt vmcnt(7)
    buffer_load_dwordx4 v[64:67], v6, s[44:47], s48 offen nt
    s_waitcnt vmcnt(7)
    buffer_load_dwordx4 v[68:71], v7, s[44:47], s48 offen nt
    s_waitcnt vmcnt(7)
    buffer_load_dwordx4 v[72:75], v8, s[44:47], s48 offen nt
    s_waitcnt vmcnt(7)
    buffer_load_dwordx4 v[76:79], v9, s[44:47], s48 offen nt
    s_mov_b32 s48, 589824
    s_waitcnt vmcnt(7)
    buffer_load_dwordx4 v[80:83], v6, s[44:47], s48 offen nt
    s_waitcnt vmcnt(7)
    buffer_load_dwordx4 v[84:87], v7, s[44:47], s48 offen nt
    s_waitcnt vmcnt(7)
    buffer_load_dwordx4 v[88:91], v8, s[44:47], s48 offen nt
    s_waitcnt vmcnt(7)
    buffer_load_dwordx4 v[92:95], v9, s[44:47], s48 offen nt
    s_mov_b32 s48, 655360
    s_waitcnt vmcnt(7)
    buffer_load_dwordx4 v[96:99], v6, s[44:47], s48 offen nt
    s_waitcnt vmcnt(7)
    buffer_load_dwordx4 v[100:103], v7, s[44:47], s48 offen nt
    s_waitcnt vmcnt(7)
    buffer_load_dwordx4 v[104:107], v8, s[44:47], s48 offen nt
    s_waitcnt vmcnt(7)
    buffer_load_dwordx4 v[108:111], v9, s[44:47], s48 offen nt
    s_mov_b32 s48, 720896
    s_waitcnt vmcnt(7)
    buffer_load_dwordx4 v[112:115], v6, s[44:47], s48 offen nt
    s_waitcnt vmcnt(7)
    buffer_load_dwordx4 v[116:119], v7, s[44:47], s48 offen nt
    s_waitcnt vmcnt(7)
    buffer_load_dwordx4 v[120:123], v8, s[44:47], s48 offen nt
    s_waitcnt vmcnt(7)
    buffer_load_dwordx4 v[124:127], v9, s[44:47], s48 offen nt
    s_mov_b32 s48, 786432
    s_waitcnt vmcnt(7)
    buffer_load_dwordx4 v[128:131], v6, s[44:47], s48 offen nt
    s_waitcnt vmcnt(7)
    buffer_load_dwordx4 v[132:135], v7, s[44:47], s48 offen nt
    s_waitcnt vmcnt(7)
    buffer_load_dwordx4 v[136:139], v8, s[44:47], s48 offen nt
    s_waitcnt vmcnt(7)
    buffer_load_dwordx4 v[140:143], v9, s[44:47], s48 offen nt
    s_barrier
    ds_read_b128 v[12:15], v11 offset:0
    s_waitcnt lgkmcnt(0)
    ds_read_b128 v[16:19], v11 offset:512
    v_and_b32 v36, v12, v32
    v_and_b32 v37, v12, v33
    v_and_b32 v38, v12, v34
    v_and_b32 v39, v12, v35
    v_and_b32 v40, v13, v32
    v_and_b32 v41, v13, v33
    v_and_b32 v42, v13, v34
    v_and_b32 v43, v13, v35
    v_mfma_f32_16x16x32_bf16 v[44:47], v[36:39], v[144:147], v[44:47]
    v_and_b32 v36, v14, v32
    v_and_b32 v37, v14, v33
    v_and_b32 v38, v14, v34
    v_and_b32 v39, v14, v35
    v_mfma_f32_16x16x32_bf16 v[44:47], v[40:43], v[148:151], v[44:47]
    v_and_b32 v40, v15, v32
    v_and_b32 v41, v15, v33
    v_and_b32 v42, v15, v34
    v_and_b32 v43, v15, v35
    v_mfma_f32_16x16x32_bf16 v[44:47], v[36:39], v[152:155], v[44:47]
    s_nop 0
    v_mfma_f32_16x16x32_bf16 v[44:47], v[40:43], v[156:159], v[44:47]
    s_mov_b32 s48, 851968
    s_waitcnt vmcnt(7)
    buffer_load_dwordx4 v[144:147], v6, s[44:47], s48 offen nt
    s_waitcnt vmcnt(7)
    buffer_load_dwordx4 v[148:151], v7, s[44:47], s48 offen nt
    s_waitcnt vmcnt(7)
    buffer_load_dwordx4 v[152:155], v8, s[44:47], s48 offen nt
    s_waitcnt vmcnt(7)
    buffer_load_dwordx4 v[156:159], v9, s[44:47], s48 offen nt
    s_waitcnt lgkmcnt(0)
    ds_read_b128 v[12:15], v11 offset:1024
    v_and_b32 v36, v16, v32
    v_and_b32 v37, v16, v33
    v_and_b32 v38, v16, v34
    v_and_b32 v39, v16, v35
    v_and_b32 v40, v17, v32
    v_and_b32 v41, v17, v33
    v_and_b32 v42, v17, v34
    v_and_b32 v43, v17, v35
    v_mfma_f32_16x16x32_bf16 v[44:47], v[36:39], v[160:163], v[44:47]
    v_and_b32 v36, v18, v32
    v_and_b32 v37, v18, v33
    v_and_b32 v38, v18, v34
    v_and_b32 v39, v18, v35
    v_mfma_f32_16x16x32_bf16 v[44:47], v[40:43], v[164:167], v[44:47]
    v_and_b32 v40, v19, v32
    v_and_b32 v41, v19, v33
    v_and_b32 v42, v19, v34
    v_and_b32 v43, v19, v35
    v_mfma_f32_16x16x32_bf16 v[44:47], v[36:39], v[168:171], v[44:47]
    s_nop 0
    v_mfma_f32_16x16x32_bf16 v[44:47], v[40:43], v[172:175], v[44:47]
    s_mov_b32 s48, 917504
    s_waitcnt vmcnt(7)
    buffer_load_dwordx4 v[160:163], v6, s[44:47], s48 offen nt
    s_waitcnt vmcnt(7)
    buffer_load_dwordx4 v[164:167], v7, s[44:47], s48 offen nt
    s_waitcnt vmcnt(7)
    buffer_load_dwordx4 v[168:171], v8, s[44:47], s48 offen nt
    s_waitcnt vmcnt(7)
    buffer_load_dwordx4 v[172:175], v9, s[44:47], s48 offen nt
    s_waitcnt lgkmcnt(0)
    ds_read_b128 v[16:19], v11 offset:1536
    v_and_b32 v36, v12, v32
    v_and_b32 v37, v12, v33
    v_and_b32 v38, v12, v34
    v_and_b32 v39, v12, v35
    v_and_b32 v40, v13, v32
    v_and_b32 v41, v13, v33
    v_and_b32 v42, v13, v34
    v_and_b32 v43, v13, v35
    v_mfma_f32_16x16x32_bf16 v[44:47], v[36:39], v[176:179], v[44:47]
    v_and_b32 v36, v14, v32
    v_and_b32 v37, v14, v33
    v_and_b32 v38, v14, v34
    v_and_b32 v39, v14, v35
    v_mfma_f32_16x16x32_bf16 v[44:47], v[40:43], v[180:183], v[44:47]
    v_and_b32 v40, v15, v32
    v_and_b32 v41, v15, v33
    v_and_b32 v42, v15, v34
    v_and_b32 v43, v15, v35
    v_mfma_f32_16x16x32_bf16 v[44:47], v[36:39], v[184:187], v[44:47]
    s_nop 0
    v_mfma_f32_16x16x32_bf16 v[44:47], v[40:43], v[188:191], v[44:47]
    s_mov_b32 s48, 983040
    s_waitcnt vmcnt(7)
    buffer_load_dwordx4 v[176:179], v6, s[44:47], s48 offen nt
    s_waitcnt vmcnt(7)
    buffer_load_dwordx4 v[180:183], v7, s[44:47], s48 offen nt
    s_waitcnt vmcnt(7)
    buffer_load_dwordx4 v[184:187], v8, s[44:47], s48 offen nt
    s_waitcnt vmcnt(7)
    buffer_load_dwordx4 v[188:191], v9, s[44:47], s48 offen nt
    s_waitcnt lgkmcnt(0)
    ds_read_b128 v[12:15], v11 offset:2048
    v_and_b32 v36, v16, v32
    v_and_b32 v37, v16, v33
    v_and_b32 v38, v16, v34
    v_and_b32 v39, v16, v35
    v_and_b32 v40, v17, v32
    v_and_b32 v41, v17, v33
    v_and_b32 v42, v17, v34
    v_and_b32 v43, v17, v35
    v_mfma_f32_16x16x32_bf16 v[44:47], v[36:39], v[192:195], v[44:47]
    v_and_b32 v36, v18, v32
    v_and_b32 v37, v18, v33
    v_and_b32 v38, v18, v34
    v_and_b32 v39, v18, v35
    v_mfma_f32_16x16x32_bf16 v[44:47], v[40:43], v[196:199], v[44:47]
    v_and_b32 v40, v19, v32
    v_and_b32 v41, v19, v33
    v_and_b32 v42, v19, v34
    v_and_b32 v43, v19, v35
    v_mfma_f32_16x16x32_bf16 v[44:47], v[36:39], v[200:203], v[44:47]
    s_nop 0
    v_mfma_f32_16x16x32_bf16 v[44:47], v[40:43], v[204:207], v[44:47]
    s_mov_b32 s48, 1048576
    s_waitcnt vmcnt(7)
    buffer_load_dwordx4 v[192:195], v6, s[44:47], s48 offen nt
    s_waitcnt vmcnt(7)
    buffer_load_dwordx4 v[196:199], v7, s[44:47], s48 offen nt
    s_waitcnt vmcnt(7)
    buffer_load_dwordx4 v[200:203], v8, s[44:47], s48 offen nt
    s_waitcnt vmcnt(7)
    buffer_load_dwordx4 v[204:207], v9, s[44:47], s48 offen nt
    s_waitcnt lgkmcnt(0)
    ds_read_b128 v[16:19], v11 offset:2560
    v_and_b32 v36, v12, v32
    v_and_b32 v37, v12, v33
    v_and_b32 v38, v12, v34
    v_and_b32 v39, v12, v35
    v_and_b32 v40, v13, v32
    v_and_b32 v41, v13, v33
    v_and_b32 v42, v13, v34
    v_and_b32 v43, v13, v35
    v_mfma_f32_16x16x32_bf16 v[44:47], v[36:39], v[208:211], v[44:47]
    v_and_b32 v36, v14, v32
    v_and_b32 v37, v14, v33
    v_and_b32 v38, v14, v34
    v_and_b32 v39, v14, v35
    v_mfma_f32_16x16x32_bf16 v[44:47], v[40:43], v[212:215], v[44:47]
    v_and_b32 v40, v15, v32
    v_and_b32 v41, v15, v33
    v_and_b32 v42, v15, v34
    v_and_b32 v43, v15, v35
    v_mfma_f32_16x16x32_bf16 v[44:47], v[36:39], v[216:219], v[44:47]
    s_nop 0
    v_mfma_f32_16x16x32_bf16 v[44:47], v[40:43], v[220:223], v[44:47]
    s_mov_b32 s48, 1114112
    s_waitcnt vmcnt(7)
    buffer_load_dwordx4 v[208:211], v6, s[44:47], s48 offen nt
    s_waitcnt vmcnt(7)
    buffer_load_dwordx4 v[212:215], v7, s[44:47], s48 offen nt
    s_waitcnt vmcnt(7)
    buffer_load_dwordx4 v[216:219], v8, s[44:47], s48 offen nt
    s_waitcnt vmcnt(7)
    buffer_load_dwordx4 v[220:223], v9, s[44:47], s48 offen nt
    s_waitcnt lgkmcnt(0)
    ds_read_b128 v[12:15], v11 offset:3072
    v_and_b32 v36, v16, v32
    v_and_b32 v37, v16, v33
    v_and_b32 v38, v16, v34
    v_and_b32 v39, v16, v35
    v_and_b32 v40, v17, v32
    v_and_b32 v41, v17, v33
    v_and_b32 v42, v17, v34
    v_and_b32 v43, v17, v35
    v_mfma_f32_16x16x32_bf16 v[44:47], v[36:39], v[224:227], v[44:47]
    v_and_b32 v36, v18, v32
    v_and_b32 v37, v18, v33
    v_and_b32 v38, v18, v34
    v_and_b32 v39, v18, v35
    v_mfma_f32_16x16x32_bf16 v[44:47], v[40:43], v[228:231], v[44:47]
    v_and_b32 v40, v19, v32
    v_and_b32 v41, v19, v33
    v_and_b32 v42, v19, v34
    v_and_b32 v43, v19, v35
    v_mfma_f32_16x16x32_bf16 v[44:47], v[36:39], v[232:235], v[44:47]
    s_nop 0
    v_mfma_f32_16x16x32_bf16 v[44:47], v[40:43], v[236:239], v[44:47]
    s_mov_b32 s48, 1179648
    s_waitcnt vmcnt(7)
    buffer_load_dwordx4 v[224:227], v6, s[44:47], s48 offen nt
    s_waitcnt vmcnt(7)
    buffer_load_dwordx4 v[228:231], v7, s[44:47], s48 offen nt
    s_waitcnt vmcnt(7)
    buffer_load_dwordx4 v[232:235], v8, s[44:47], s48 offen nt
    s_waitcnt vmcnt(7)
    buffer_load_dwordx4 v[236:239], v9, s[44:47], s48 offen nt
    s_waitcnt lgkmcnt(0)
    ds_read_b128 v[16:19], v11 offset:3584
    v_and_b32 v36, v12, v32
    v_and_b32 v37, v12, v33
    v_and_b32 v38, v12, v34
    v_and_b32 v39, v12, v35
    v_and_b32 v40, v13, v32
    v_and_b32 v41, v13, v33
    v_and_b32 v42, v13, v34
    v_and_b32 v43, v13, v35
    v_mfma_f32_16x16x32_bf16 v[44:47], v[36:39], v[240:243], v[44:47]
    v_and_b32 v36, v14, v32
    v_and_b32 v37, v14, v33
    v_and_b32 v38, v14, v34
    v_and_b32 v39, v14, v35
    v_mfma_f32_16x16x32_bf16 v[44:47], v[40:43], v[244:247], v[44:47]
    v_and_b32 v40, v15, v32
    v_and_b32 v41, v15, v33
    v_and_b32 v42, v15, v34
    v_and_b32 v43, v15, v35
    v_mfma_f32_16x16x32_bf16 v[44:47], v[36:39], v[248:251], v[44:47]
    s_nop 0
    v_mfma_f32_16x16x32_bf16 v[44:47], v[40:43], v[252:255], v[44:47]
    s_mov_b32 s48, 1245184
    s_waitcnt vmcnt(7)
    buffer_load_dwordx4 v[240:243], v6, s[44:47], s48 offen nt
    s_waitcnt vmcnt(7)
    buffer_load_dwordx4 v[244:247], v7, s[44:47], s48 offen nt
    s_waitcnt vmcnt(7)
    buffer_load_dwordx4 v[248:251], v8, s[44:47], s48 offen nt
    s_waitcnt vmcnt(7)
    buffer_load_dwordx4 v[252:255], v9, s[44:47], s48 offen nt
    s_waitcnt lgkmcnt(0)
    ds_read_b128 v[12:15], v11 offset:4096
    v_and_b32 v36, v16, v32
    v_and_b32 v37, v16, v33
    v_and_b32 v38, v16, v34
    v_and_b32 v39, v16, v35
    v_and_b32 v40, v17, v32
    v_and_b32 v41, v17, v33
    v_and_b32 v42, v17, v34
    v_and_b32 v43, v17, v35
    v_mfma_f32_16x16x32_bf16 v[44:47], v[36:39], v[48:51], v[44:47]
    v_and_b32 v36, v18, v32
    v_and_b32 v37, v18, v33
    v_and_b32 v38, v18, v34
    v_and_b32 v39, v18, v35
    v_mfma_f32_16x16x32_bf16 v[44:47], v[40:43], v[52:55], v[44:47]
    v_and_b32 v40, v19, v32
    v_and_b32 v41, v19, v33
    v_and_b32 v42, v19, v34
    v_and_b32 v43, v19, v35
    v_mfma_f32_16x16x32_bf16 v[44:47], v[36:39], v[56:59], v[44:47]
    s_nop 0
    v_mfma_f32_16x16x32_bf16 v[44:47], v[40:43], v[60:63], v[44:47]
    s_mov_b32 s48, 1310720
    s_waitcnt vmcnt(7)
    buffer_load_dwordx4 v[48:51], v6, s[44:47], s48 offen nt
    s_waitcnt vmcnt(7)
    buffer_load_dwordx4 v[52:55], v7, s[44:47], s48 offen nt
    s_waitcnt vmcnt(7)
    buffer_load_dwordx4 v[56:59], v8, s[44:47], s48 offen nt
    s_waitcnt vmcnt(7)
    buffer_load_dwordx4 v[60:63], v9, s[44:47], s48 offen nt
    s_waitcnt lgkmcnt(0)
    ds_read_b128 v[16:19], v11 offset:4608
    v_and_b32 v36, v12, v32
    v_and_b32 v37, v12, v33
    v_and_b32 v38, v12, v34
    v_and_b32 v39, v12, v35
    v_and_b32 v40, v13, v32
    v_and_b32 v41, v13, v33
    v_and_b32 v42, v13, v34
    v_and_b32 v43, v13, v35
    v_mfma_f32_16x16x32_bf16 v[44:47], v[36:39], v[64:67], v[44:47]
    v_and_b32 v36, v14, v32
    v_and_b32 v37, v14, v33
    v_and_b32 v38, v14, v34
    v_and_b32 v39, v14, v35
    v_mfma_f32_16x16x32_bf16 v[44:47], v[40:43], v[68:71], v[44:47]
    v_and_b32 v40, v15, v32
    v_and_b32 v41, v15, v33
    v_and_b32 v42, v15, v34
    v_and_b32 v43, v15, v35
    v_mfma_f32_16x16x32_bf16 v[44:47], v[36:39], v[72:75], v[44:47]
    s_nop 0
    v_mfma_f32_16x16x32_bf16 v[44:47], v[40:43], v[76:79], v[44:47]
    s_mov_b32 s48, 1376256
    s_waitcnt vmcnt(7)
    buffer_load_dwordx4 v[64:67], v6, s[44:47], s48 offen nt
    s_waitcnt vmcnt(7)
    buffer_load_dwordx4 v[68:71], v7, s[44:47], s48 offen nt
    s_waitcnt vmcnt(7)
    buffer_load_dwordx4 v[72:75], v8, s[44:47], s48 offen nt
    s_waitcnt vmcnt(7)
    buffer_load_dwordx4 v[76:79], v9, s[44:47], s48 offen nt
    s_waitcnt lgkmcnt(0)
    ds_read_b128 v[12:15], v11 offset:5120
    v_and_b32 v36, v16, v32
    v_and_b32 v37, v16, v33
    v_and_b32 v38, v16, v34
    v_and_b32 v39, v16, v35
    v_and_b32 v40, v17, v32
    v_and_b32 v41, v17, v33
    v_and_b32 v42, v17, v34
    v_and_b32 v43, v17, v35
    v_mfma_f32_16x16x32_bf16 v[44:47], v[36:39], v[80:83], v[44:47]
    v_and_b32 v36, v18, v32
    v_and_b32 v37, v18, v33
    v_and_b32 v38, v18, v34
    v_and_b32 v39, v18, v35
    v_mfma_f32_16x16x32_bf16 v[44:47], v[40:43], v[84:87], v[44:47]
    v_and_b32 v40, v19, v32
    v_and_b32 v41, v19, v33
    v_and_b32 v42, v19, v34
    v_and_b32 v43, v19, v35
    v_mfma_f32_16x16x32_bf16 v[44:47], v[36:39], v[88:91], v[44:47]
    s_nop 0
    v_mfma_f32_16x16x32_bf16 v[44:47], v[40:43], v[92:95], v[44:47]
    s_mov_b32 s48, 1441792
    s_waitcnt vmcnt(7)
    buffer_load_dwordx4 v[80:83], v6, s[44:47], s48 offen nt
    s_waitcnt vmcnt(7)
    buffer_load_dwordx4 v[84:87], v7, s[44:47], s48 offen nt
    s_waitcnt vmcnt(7)
    buffer_load_dwordx4 v[88:91], v8, s[44:47], s48 offen nt
    s_waitcnt vmcnt(7)
    buffer_load_dwordx4 v[92:95], v9, s[44:47], s48 offen nt
    s_waitcnt lgkmcnt(0)
    ds_read_b128 v[16:19], v11 offset:5632
    v_and_b32 v36, v12, v32
    v_and_b32 v37, v12, v33
    v_and_b32 v38, v12, v34
    v_and_b32 v39, v12, v35
    v_and_b32 v40, v13, v32
    v_and_b32 v41, v13, v33
    v_and_b32 v42, v13, v34
    v_and_b32 v43, v13, v35
    v_mfma_f32_16x16x32_bf16 v[44:47], v[36:39], v[96:99], v[44:47]
    v_and_b32 v36, v14, v32
    v_and_b32 v37, v14, v33
    v_and_b32 v38, v14, v34
    v_and_b32 v39, v14, v35
    v_mfma_f32_16x16x32_bf16 v[44:47], v[40:43], v[100:103], v[44:47]
    v_and_b32 v40, v15, v32
    v_and_b32 v41, v15, v33
    v_and_b32 v42, v15, v34
    v_and_b32 v43, v15, v35
    v_mfma_f32_16x16x32_bf16 v[44:47], v[36:39], v[104:107], v[44:47]
    s_nop 0
    v_mfma_f32_16x16x32_bf16 v[44:47], v[40:43], v[108:111], v[44:47]
    s_mov_b32 s48, 1507328
    s_waitcnt vmcnt(7)
    buffer_load_dwordx4 v[96:99], v6, s[44:47], s48 offen nt
    s_waitcnt vmcnt(7)
    buffer_load_dwordx4 v[100:103], v7, s[44:47], s48 offen nt
    s_waitcnt vmcnt(7)
    buffer_load_dwordx4 v[104:107], v8, s[44:47], s48 offen nt
    s_waitcnt vmcnt(7)
    buffer_load_dwordx4 v[108:111], v9, s[44:47], s48 offen nt
    s_waitcnt lgkmcnt(0)
    ds_read_b128 v[12:15], v11 offset:6144
    v_and_b32 v36, v16, v32
    v_and_b32 v37, v16, v33
    v_and_b32 v38, v16, v34
    v_and_b32 v39, v16, v35
    v_and_b32 v40, v17, v32
    v_and_b32 v41, v17, v33
    v_and_b32 v42, v17, v34
    v_and_b32 v43, v17, v35
    v_mfma_f32_16x16x32_bf16 v[44:47], v[36:39], v[112:115], v[44:47]
    v_and_b32 v36, v18, v32
    v_and_b32 v37, v18, v33
    v_and_b32 v38, v18, v34
    v_and_b32 v39, v18, v35
    v_mfma_f32_16x16x32_bf16 v[44:47], v[40:43], v[116:119], v[44:47]
    v_and_b32 v40, v19, v32
    v_and_b32 v41, v19, v33
    v_and_b32 v42, v19, v34
    v_and_b32 v43, v19, v35
    v_mfma_f32_16x16x32_bf16 v[44:47], v[36:39], v[120:123], v[44:47]
    s_nop 0
    v_mfma_f32_16x16x32_bf16 v[44:47], v[40:43], v[124:127], v[44:47]
    s_mov_b32 s48, 1572864
    s_waitcnt vmcnt(7)
    buffer_load_dwordx4 v[112:115], v6, s[44:47], s48 offen nt
    s_waitcnt vmcnt(7)
    buffer_load_dwordx4 v[116:119], v7, s[44:47], s48 offen nt
    s_waitcnt vmcnt(7)
    buffer_load_dwordx4 v[120:123], v8, s[44:47], s48 offen nt
    s_waitcnt vmcnt(7)
    buffer_load_dwordx4 v[124:127], v9, s[44:47], s48 offen nt
    s_waitcnt lgkmcnt(0)
    ds_read_b128 v[16:19], v11 offset:6656
    v_and_b32 v36, v12, v32
    v_and_b32 v37, v12, v33
    v_and_b32 v38, v12, v34
    v_and_b32 v39, v12, v35
    v_and_b32 v40, v13, v32
    v_and_b32 v41, v13, v33
    v_and_b32 v42, v13, v34
    v_and_b32 v43, v13, v35
    v_mfma_f32_16x16x32_bf16 v[44:47], v[36:39], v[128:131], v[44:47]
    v_and_b32 v36, v14, v32
    v_and_b32 v37, v14, v33
    v_and_b32 v38, v14, v34
    v_and_b32 v39, v14, v35
    v_mfma_f32_16x16x32_bf16 v[44:47], v[40:43], v[132:135], v[44:47]
    v_and_b32 v40, v15, v32
    v_and_b32 v41, v15, v33
    v_and_b32 v42, v15, v34
    v_and_b32 v43, v15, v35
    v_mfma_f32_16x16x32_bf16 v[44:47], v[36:39], v[136:139], v[44:47]
    s_nop 0
    v_mfma_f32_16x16x32_bf16 v[44:47], v[40:43], v[140:143], v[44:47]
    s_mov_b32 s48, 1638400
    s_waitcnt vmcnt(7)
    buffer_load_dwordx4 v[128:131], v6, s[44:47], s48 offen nt
    s_waitcnt vmcnt(7)
    buffer_load_dwordx4 v[132:135], v7, s[44:47], s48 offen nt
    s_waitcnt vmcnt(7)
    buffer_load_dwordx4 v[136:139], v8, s[44:47], s48 offen nt
    s_waitcnt vmcnt(7)
    buffer_load_dwordx4 v[140:143], v9, s[44:47], s48 offen nt
    s_waitcnt lgkmcnt(0)
    ds_read_b128 v[12:15], v11 offset:7168
    v_and_b32 v36, v16, v32
    v_and_b32 v37, v16, v33
    v_and_b32 v38, v16, v34
    v_and_b32 v39, v16, v35
    v_and_b32 v40, v17, v32
    v_and_b32 v41, v17, v33
    v_and_b32 v42, v17, v34
    v_and_b32 v43, v17, v35
    v_mfma_f32_16x16x32_bf16 v[44:47], v[36:39], v[144:147], v[44:47]
    v_and_b32 v36, v18, v32
    v_and_b32 v37, v18, v33
    v_and_b32 v38, v18, v34
    v_and_b32 v39, v18, v35
    v_mfma_f32_16x16x32_bf16 v[44:47], v[40:43], v[148:151], v[44:47]
    v_and_b32 v40, v19, v32
    v_and_b32 v41, v19, v33
    v_and_b32 v42, v19, v34
    v_and_b32 v43, v19, v35
    v_mfma_f32_16x16x32_bf16 v[44:47], v[36:39], v[152:155], v[44:47]
    s_nop 0
    v_mfma_f32_16x16x32_bf16 v[44:47], v[40:43], v[156:159], v[44:47]
    s_mov_b32 s48, 1703936
    s_waitcnt vmcnt(7)
    buffer_load_dwordx4 v[144:147], v6, s[44:47], s48 offen nt
    s_waitcnt vmcnt(7)
    buffer_load_dwordx4 v[148:151], v7, s[44:47], s48 offen nt
    s_waitcnt vmcnt(7)
    buffer_load_dwordx4 v[152:155], v8, s[44:47], s48 offen nt
    s_waitcnt vmcnt(7)
    buffer_load_dwordx4 v[156:159], v9, s[44:47], s48 offen nt
    s_waitcnt lgkmcnt(0)
    ds_read_b128 v[16:19], v11 offset:7680
    v_and_b32 v36, v12, v32
    v_and_b32 v37, v12, v33
    v_and_b32 v38, v12, v34
    v_and_b32 v39, v12, v35
    v_and_b32 v40, v13, v32
    v_and_b32 v41, v13, v33
    v_and_b32 v42, v13, v34
    v_and_b32 v43, v13, v35
    v_mfma_f32_16x16x32_bf16 v[44:47], v[36:39], v[160:163], v[44:47]
    v_and_b32 v36, v14, v32
    v_and_b32 v37, v14, v33
    v_and_b32 v38, v14, v34
    v_and_b32 v39, v14, v35
    v_mfma_f32_16x16x32_bf16 v[44:47], v[40:43], v[164:167], v[44:47]
    v_and_b32 v40, v15, v32
    v_and_b32 v41, v15, v33
    v_and_b32 v42, v15, v34
    v_and_b32 v43, v15, v35
    v_mfma_f32_16x16x32_bf16 v[44:47], v[36:39], v[168:171], v[44:47]
    s_nop 0
    v_mfma_f32_16x16x32_bf16 v[44:47], v[40:43], v[172:175], v[44:47]
    s_mov_b32 s48, 1769472
    s_waitcnt vmcnt(7)
    buffer_load_dwordx4 v[160:163], v6, s[44:47], s48 offen nt
    s_waitcnt vmcnt(7)
    buffer_load_dwordx4 v[164:167], v7, s[44:47], s48 offen nt
    s_waitcnt vmcnt(7)
    buffer_load_dwordx4 v[168:171], v8, s[44:47], s48 offen nt
    s_waitcnt vmcnt(7)
    buffer_load_dwordx4 v[172:175], v9, s[44:47], s48 offen nt
    s_waitcnt lgkmcnt(0)
    ds_read_b128 v[12:15], v11 offset:8192
    v_and_b32 v36, v16, v32
    v_and_b32 v37, v16, v33
    v_and_b32 v38, v16, v34
    v_and_b32 v39, v16, v35
    v_and_b32 v40, v17, v32
    v_and_b32 v41, v17, v33
    v_and_b32 v42, v17, v34
    v_and_b32 v43, v17, v35
    v_mfma_f32_16x16x32_bf16 v[44:47], v[36:39], v[176:179], v[44:47]
    v_and_b32 v36, v18, v32
    v_and_b32 v37, v18, v33
    v_and_b32 v38, v18, v34
    v_and_b32 v39, v18, v35
    v_mfma_f32_16x16x32_bf16 v[44:47], v[40:43], v[180:183], v[44:47]
    v_and_b32 v40, v19, v32
    v_and_b32 v41, v19, v33
    v_and_b32 v42, v19, v34
    v_and_b32 v43, v19, v35
    v_mfma_f32_16x16x32_bf16 v[44:47], v[36:39], v[184:187], v[44:47]
    s_nop 0
    v_mfma_f32_16x16x32_bf16 v[44:47], v[40:43], v[188:191], v[44:47]
    s_mov_b32 s48, 1835008
    s_waitcnt vmcnt(7)
    buffer_load_dwordx4 v[176:179], v6, s[44:47], s48 offen nt
    s_waitcnt vmcnt(7)
    buffer_load_dwordx4 v[180:183], v7, s[44:47], s48 offen nt
    s_waitcnt vmcnt(7)
    buffer_load_dwordx4 v[184:187], v8, s[44:47], s48 offen nt
    s_waitcnt vmcnt(7)
    buffer_load_dwordx4 v[188:191], v9, s[44:47], s48 offen nt
    s_waitcnt lgkmcnt(0)
    ds_read_b128 v[16:19], v11 offset:8704
    v_and_b32 v36, v12, v32
    v_and_b32 v37, v12, v33
    v_and_b32 v38, v12, v34
    v_and_b32 v39, v12, v35
    v_and_b32 v40, v13, v32
    v_and_b32 v41, v13, v33
    v_and_b32 v42, v13, v34
    v_and_b32 v43, v13, v35
    v_mfma_f32_16x16x32_bf16 v[44:47], v[36:39], v[192:195], v[44:47]
    v_and_b32 v36, v14, v32
    v_and_b32 v37, v14, v33
    v_and_b32 v38, v14, v34
    v_and_b32 v39, v14, v35
    v_mfma_f32_16x16x32_bf16 v[44:47], v[40:43], v[196:199], v[44:47]
    v_and_b32 v40, v15, v32
    v_and_b32 v41, v15, v33
    v_and_b32 v42, v15, v34
    v_and_b32 v43, v15, v35
    v_mfma_f32_16x16x32_bf16 v[44:47], v[36:39], v[200:203], v[44:47]
    s_nop 0
    v_mfma_f32_16x16x32_bf16 v[44:47], v[40:43], v[204:207], v[44:47]
    s_mov_b32 s48, 1900544
    s_waitcnt vmcnt(7)
    buffer_load_dwordx4 v[192:195], v6, s[44:47], s48 offen nt
    s_waitcnt vmcnt(7)
    buffer_load_dwordx4 v[196:199], v7, s[44:47], s48 offen nt
    s_waitcnt vmcnt(7)
    buffer_load_dwordx4 v[200:203], v8, s[44:47], s48 offen nt
    s_waitcnt vmcnt(7)
    buffer_load_dwordx4 v[204:207], v9, s[44:47], s48 offen nt
    s_waitcnt lgkmcnt(0)
    ds_read_b128 v[12:15], v11 offset:9216
    v_and_b32 v36, v16, v32
    v_and_b32 v37, v16, v33
    v_and_b32 v38, v16, v34
    v_and_b32 v39, v16, v35
    v_and_b32 v40, v17, v32
    v_and_b32 v41, v17, v33
    v_and_b32 v42, v17, v34
    v_and_b32 v43, v17, v35
    v_mfma_f32_16x16x32_bf16 v[44:47], v[36:39], v[208:211], v[44:47]
    v_and_b32 v36, v18, v32
    v_and_b32 v37, v18, v33
    v_and_b32 v38, v18, v34
    v_and_b32 v39, v18, v35
    v_mfma_f32_16x16x32_bf16 v[44:47], v[40:43], v[212:215], v[44:47]
    v_and_b32 v40, v19, v32
    v_and_b32 v41, v19, v33
    v_and_b32 v42, v19, v34
    v_and_b32 v43, v19, v35
    v_mfma_f32_16x16x32_bf16 v[44:47], v[36:39], v[216:219], v[44:47]
    s_nop 0
    v_mfma_f32_16x16x32_bf16 v[44:47], v[40:43], v[220:223], v[44:47]
    s_mov_b32 s48, 1966080
    s_waitcnt vmcnt(7)
    buffer_load_dwordx4 v[208:211], v6, s[44:47], s48 offen nt
    s_waitcnt vmcnt(7)
    buffer_load_dwordx4 v[212:215], v7, s[44:47], s48 offen nt
    s_waitcnt vmcnt(7)
    buffer_load_dwordx4 v[216:219], v8, s[44:47], s48 offen nt
    s_waitcnt vmcnt(7)
    buffer_load_dwordx4 v[220:223], v9, s[44:47], s48 offen nt
    s_waitcnt lgkmcnt(0)
    ds_read_b128 v[16:19], v11 offset:9728
    v_and_b32 v36, v12, v32
    v_and_b32 v37, v12, v33
    v_and_b32 v38, v12, v34
    v_and_b32 v39, v12, v35
    v_and_b32 v40, v13, v32
    v_and_b32 v41, v13, v33
    v_and_b32 v42, v13, v34
    v_and_b32 v43, v13, v35
    v_mfma_f32_16x16x32_bf16 v[44:47], v[36:39], v[224:227], v[44:47]
    v_and_b32 v36, v14, v32
    v_and_b32 v37, v14, v33
    v_and_b32 v38, v14, v34
    v_and_b32 v39, v14, v35
    v_mfma_f32_16x16x32_bf16 v[44:47], v[40:43], v[228:231], v[44:47]
    v_and_b32 v40, v15, v32
    v_and_b32 v41, v15, v33
    v_and_b32 v42, v15, v34
    v_and_b32 v43, v15, v35
    v_mfma_f32_16x16x32_bf16 v[44:47], v[36:39], v[232:235], v[44:47]
    s_nop 0
    v_mfma_f32_16x16x32_bf16 v[44:47], v[40:43], v[236:239], v[44:47]
    s_mov_b32 s48, 2031616
    s_waitcnt vmcnt(7)
    buffer_load_dwordx4 v[224:227], v6, s[44:47], s48 offen nt
    s_waitcnt vmcnt(7)
    buffer_load_dwordx4 v[228:231], v7, s[44:47], s48 offen nt
    s_waitcnt vmcnt(7)
    buffer_load_dwordx4 v[232:235], v8, s[44:47], s48 offen nt
    s_waitcnt vmcnt(7)
    buffer_load_dwordx4 v[236:239], v9, s[44:47], s48 offen nt
    s_waitcnt lgkmcnt(0)
    ds_read_b128 v[12:15], v11 offset:10240
    v_and_b32 v36, v16, v32
    v_and_b32 v37, v16, v33
    v_and_b32 v38, v16, v34
    v_and_b32 v39, v16, v35
    v_and_b32 v40, v17, v32
    v_and_b32 v41, v17, v33
    v_and_b32 v42, v17, v34
    v_and_b32 v43, v17, v35
    v_mfma_f32_16x16x32_bf16 v[44:47], v[36:39], v[240:243], v[44:47]
    v_and_b32 v36, v18, v32
    v_and_b32 v37, v18, v33
    v_and_b32 v38, v18, v34
    v_and_b32 v39, v18, v35
    v_mfma_f32_16x16x32_bf16 v[44:47], v[40:43], v[244:247], v[44:47]
    v_and_b32 v40, v19, v32
    v_and_b32 v41, v19, v33
    v_and_b32 v42, v19, v34
    v_and_b32 v43, v19, v35
    v_mfma_f32_16x16x32_bf16 v[44:47], v[36:39], v[248:251], v[44:47]
    s_nop 0
    v_mfma_f32_16x16x32_bf16 v[44:47], v[40:43], v[252:255], v[44:47]
    s_waitcnt lgkmcnt(0)
    ds_read_b128 v[16:19], v11 offset:10752
    v_and_b32 v36, v12, v32
    v_and_b32 v37, v12, v33
    v_and_b32 v38, v12, v34
    v_and_b32 v39, v12, v35
    v_and_b32 v40, v13, v32
    v_and_b32 v41, v13, v33
    v_and_b32 v42, v13, v34
    v_and_b32 v43, v13, v35
    v_mfma_f32_16x16x32_bf16 v[44:47], v[36:39], v[48:51], v[44:47]
    v_and_b32 v36, v14, v32
    v_and_b32 v37, v14, v33
    v_and_b32 v38, v14, v34
    v_and_b32 v39, v14, v35
    v_mfma_f32_16x16x32_bf16 v[44:47], v[40:43], v[52:55], v[44:47]
    v_and_b32 v40, v15, v32
    v_and_b32 v41, v15, v33
    v_and_b32 v42, v15, v34
    v_and_b32 v43, v15, v35
    v_mfma_f32_16x16x32_bf16 v[44:47], v[36:39], v[56:59], v[44:47]
    s_nop 0
    v_mfma_f32_16x16x32_bf16 v[44:47], v[40:43], v[60:63], v[44:47]
    s_waitcnt lgkmcnt(0)
    ds_read_b128 v[12:15], v11 offset:11264
    v_and_b32 v36, v16, v32
    v_and_b32 v37, v16, v33
    v_and_b32 v38, v16, v34
    v_and_b32 v39, v16, v35
    v_and_b32 v40, v17, v32
    v_and_b32 v41, v17, v33
    v_and_b32 v42, v17, v34
    v_and_b32 v43, v17, v35
    v_mfma_f32_16x16x32_bf16 v[44:47], v[36:39], v[64:67], v[44:47]
    v_and_b32 v36, v18, v32
    v_and_b32 v37, v18, v33
    v_and_b32 v38, v18, v34
    v_and_b32 v39, v18, v35
    v_mfma_f32_16x16x32_bf16 v[44:47], v[40:43], v[68:71], v[44:47]
    v_and_b32 v40, v19, v32
    v_and_b32 v41, v19, v33
    v_and_b32 v42, v19, v34
    v_and_b32 v43, v19, v35
    v_mfma_f32_16x16x32_bf16 v[44:47], v[36:39], v[72:75], v[44:47]
    s_nop 0
    v_mfma_f32_16x16x32_bf16 v[44:47], v[40:43], v[76:79], v[44:47]
    s_waitcnt lgkmcnt(0)
    ds_read_b128 v[16:19], v11 offset:11776
    v_and_b32 v36, v12, v32
    v_and_b32 v37, v12, v33
    v_and_b32 v38, v12, v34
    v_and_b32 v39, v12, v35
    v_and_b32 v40, v13, v32
    v_and_b32 v41, v13, v33
    v_and_b32 v42, v13, v34
    v_and_b32 v43, v13, v35
    v_mfma_f32_16x16x32_bf16 v[44:47], v[36:39], v[80:83], v[44:47]
    v_and_b32 v36, v14, v32
    v_and_b32 v37, v14, v33
    v_and_b32 v38, v14, v34
    v_and_b32 v39, v14, v35
    v_mfma_f32_16x16x32_bf16 v[44:47], v[40:43], v[84:87], v[44:47]
    v_and_b32 v40, v15, v32
    v_and_b32 v41, v15, v33
    v_and_b32 v42, v15, v34
    v_and_b32 v43, v15, v35
    v_mfma_f32_16x16x32_bf16 v[44:47], v[36:39], v[88:91], v[44:47]
    s_nop 0
    v_mfma_f32_16x16x32_bf16 v[44:47], v[40:43], v[92:95], v[44:47]
    s_waitcnt lgkmcnt(0)
    ds_read_b128 v[12:15], v11 offset:12288
    v_and_b32 v36, v16, v32
    v_and_b32 v37, v16, v33
    v_and_b32 v38, v16, v34
    v_and_b32 v39, v16, v35
    v_and_b32 v40, v17, v32
    v_and_b32 v41, v17, v33
    v_and_b32 v42, v17, v34
    v_and_b32 v43, v17, v35
    v_mfma_f32_16x16x32_bf16 v[44:47], v[36:39], v[96:99], v[44:47]
    v_and_b32 v36, v18, v32
    v_and_b32 v37, v18, v33
    v_and_b32 v38, v18, v34
    v_and_b32 v39, v18, v35
    v_mfma_f32_16x16x32_bf16 v[44:47], v[40:43], v[100:103], v[44:47]
    v_and_b32 v40, v19, v32
    v_and_b32 v41, v19, v33
    v_and_b32 v42, v19, v34
    v_and_b32 v43, v19, v35
    v_mfma_f32_16x16x32_bf16 v[44:47], v[36:39], v[104:107], v[44:47]
    s_nop 0
    v_mfma_f32_16x16x32_bf16 v[44:47], v[40:43], v[108:111], v[44:47]
    s_waitcnt lgkmcnt(0)
    ds_read_b128 v[16:19], v11 offset:12800
    v_and_b32 v36, v12, v32
    v_and_b32 v37, v12, v33
    v_and_b32 v38, v12, v34
    v_and_b32 v39, v12, v35
    v_and_b32 v40, v13, v32
    v_and_b32 v41, v13, v33
    v_and_b32 v42, v13, v34
    v_and_b32 v43, v13, v35
    v_mfma_f32_16x16x32_bf16 v[44:47], v[36:39], v[112:115], v[44:47]
    v_and_b32 v36, v14, v32
    v_and_b32 v37, v14, v33
    v_and_b32 v38, v14, v34
    v_and_b32 v39, v14, v35
    v_mfma_f32_16x16x32_bf16 v[44:47], v[40:43], v[116:119], v[44:47]
    v_and_b32 v40, v15, v32
    v_and_b32 v41, v15, v33
    v_and_b32 v42, v15, v34
    v_and_b32 v43, v15, v35
    v_mfma_f32_16x16x32_bf16 v[44:47], v[36:39], v[120:123], v[44:47]
    s_nop 0
    v_mfma_f32_16x16x32_bf16 v[44:47], v[40:43], v[124:127], v[44:47]
    s_waitcnt lgkmcnt(0)
    ds_read_b128 v[12:15], v11 offset:13312
    v_and_b32 v36, v16, v32
    v_and_b32 v37, v16, v33
    v_and_b32 v38, v16, v34
    v_and_b32 v39, v16, v35
    v_and_b32 v40, v17, v32
    v_and_b32 v41, v17, v33
    v_and_b32 v42, v17, v34
    v_and_b32 v43, v17, v35
    v_mfma_f32_16x16x32_bf16 v[44:47], v[36:39], v[128:131], v[44:47]
    v_and_b32 v36, v18, v32
    v_and_b32 v37, v18, v33
    v_and_b32 v38, v18, v34
    v_and_b32 v39, v18, v35
    v_mfma_f32_16x16x32_bf16 v[44:47], v[40:43], v[132:135], v[44:47]
    v_and_b32 v40, v19, v32
    v_and_b32 v41, v19, v33
    v_and_b32 v42, v19, v34
    v_and_b32 v43, v19, v35
    v_mfma_f32_16x16x32_bf16 v[44:47], v[36:39], v[136:139], v[44:47]
    s_nop 0
    v_mfma_f32_16x16x32_bf16 v[44:47], v[40:43], v[140:143], v[44:47]
    s_waitcnt lgkmcnt(0)
    ds_read_b128 v[16:19], v11 offset:13824
    v_and_b32 v36, v12, v32
    v_and_b32 v37, v12, v33
    v_and_b32 v38, v12, v34
    v_and_b32 v39, v12, v35
    v_and_b32 v40, v13, v32
    v_and_b32 v41, v13, v33
    v_and_b32 v42, v13, v34
    v_and_b32 v43, v13, v35
    v_mfma_f32_16x16x32_bf16 v[44:47], v[36:39], v[144:147], v[44:47]
    v_and_b32 v36, v14, v32
    v_and_b32 v37, v14, v33
    v_and_b32 v38, v14, v34
    v_and_b32 v39, v14, v35
    v_mfma_f32_16x16x32_bf16 v[44:47], v[40:43], v[148:151], v[44:47]
    v_and_b32 v40, v15, v32
    v_and_b32 v41, v15, v33
    v_and_b32 v42, v15, v34
    v_and_b32 v43, v15, v35
    v_mfma_f32_16x16x32_bf16 v[44:47], v[36:39], v[152:155], v[44:47]
    s_nop 0
    v_mfma_f32_16x16x32_bf16 v[44:47], v[40:43], v[156:159], v[44:47]
    s_waitcnt lgkmcnt(0)
    ds_read_b128 v[12:15], v11 offset:14336
    v_and_b32 v36, v16, v32
    v_and_b32 v37, v16, v33
    v_and_b32 v38, v16, v34
    v_and_b32 v39, v16, v35
    v_and_b32 v40, v17, v32
    v_and_b32 v41, v17, v33
    v_and_b32 v42, v17, v34
    v_and_b32 v43, v17, v35
    v_mfma_f32_16x16x32_bf16 v[44:47], v[36:39], v[160:163], v[44:47]
    v_and_b32 v36, v18, v32
    v_and_b32 v37, v18, v33
    v_and_b32 v38, v18, v34
    v_and_b32 v39, v18, v35
    v_mfma_f32_16x16x32_bf16 v[44:47], v[40:43], v[164:167], v[44:47]
    v_and_b32 v40, v19, v32
    v_and_b32 v41, v19, v33
    v_and_b32 v42, v19, v34
    v_and_b32 v43, v19, v35
    v_mfma_f32_16x16x32_bf16 v[44:47], v[36:39], v[168:171], v[44:47]
    s_nop 0
    v_mfma_f32_16x16x32_bf16 v[44:47], v[40:43], v[172:175], v[44:47]
    s_waitcnt lgkmcnt(0)
    ds_read_b128 v[16:19], v11 offset:14848
    v_and_b32 v36, v12, v32
    v_and_b32 v37, v12, v33
    v_and_b32 v38, v12, v34
    v_and_b32 v39, v12, v35
    v_and_b32 v40, v13, v32
    v_and_b32 v41, v13, v33
    v_and_b32 v42, v13, v34
    v_and_b32 v43, v13, v35
    v_mfma_f32_16x16x32_bf16 v[44:47], v[36:39], v[176:179], v[44:47]
    v_and_b32 v36, v14, v32
    v_and_b32 v37, v14, v33
    v_and_b32 v38, v14, v34
    v_and_b32 v39, v14, v35
    v_mfma_f32_16x16x32_bf16 v[44:47], v[40:43], v[180:183], v[44:47]
    v_and_b32 v40, v15, v32
    v_and_b32 v41, v15, v33
    v_and_b32 v42, v15, v34
    v_and_b32 v43, v15, v35
    v_mfma_f32_16x16x32_bf16 v[44:47], v[36:39], v[184:187], v[44:47]
    s_nop 0
    v_mfma_f32_16x16x32_bf16 v[44:47], v[40:43], v[188:191], v[44:47]
    s_waitcnt lgkmcnt(0)
    ds_read_b128 v[12:15], v11 offset:15360
    v_and_b32 v36, v16, v32
    v_and_b32 v37, v16, v33
    v_and_b32 v38, v16, v34
    v_and_b32 v39, v16, v35
    v_and_b32 v40, v17, v32
    v_and_b32 v41, v17, v33
    v_and_b32 v42, v17, v34
    v_and_b32 v43, v17, v35
    v_mfma_f32_16x16x32_bf16 v[44:47], v[36:39], v[192:195], v[44:47]
    v_and_b32 v36, v18, v32
    v_and_b32 v37, v18, v33
    v_and_b32 v38, v18, v34
    v_and_b32 v39, v18, v35
    v_mfma_f32_16x16x32_bf16 v[44:47], v[40:43], v[196:199], v[44:47]
    v_and_b32 v40, v19, v32
    v_and_b32 v41, v19, v33
    v_and_b32 v42, v19, v34
    v_and_b32 v43, v19, v35
    v_mfma_f32_16x16x32_bf16 v[44:47], v[36:39], v[200:203], v[44:47]
    s_nop 0
    v_mfma_f32_16x16x32_bf16 v[44:47], v[40:43], v[204:207], v[44:47]
    s_waitcnt lgkmcnt(0)
    ds_read_b128 v[16:19], v11 offset:15872
    s_waitcnt vmcnt(4)
    v_and_b32 v36, v12, v32
    v_and_b32 v37, v12, v33
    v_and_b32 v38, v12, v34
    v_and_b32 v39, v12, v35
    v_and_b32 v40, v13, v32
    v_and_b32 v41, v13, v33
    v_and_b32 v42, v13, v34
    v_and_b32 v43, v13, v35
    v_mfma_f32_16x16x32_bf16 v[44:47], v[36:39], v[208:211], v[44:47]
    v_and_b32 v36, v14, v32
    v_and_b32 v37, v14, v33
    v_and_b32 v38, v14, v34
    v_and_b32 v39, v14, v35
    v_mfma_f32_16x16x32_bf16 v[44:47], v[40:43], v[212:215], v[44:47]
    v_and_b32 v40, v15, v32
    v_and_b32 v41, v15, v33
    v_and_b32 v42, v15, v34
    v_and_b32 v43, v15, v35
    v_mfma_f32_16x16x32_bf16 v[44:47], v[36:39], v[216:219], v[44:47]
    s_nop 0
    v_mfma_f32_16x16x32_bf16 v[44:47], v[40:43], v[220:223], v[44:47]
    s_waitcnt lgkmcnt(0)
    s_waitcnt vmcnt(0)
    v_and_b32 v36, v16, v32
    v_and_b32 v37, v16, v33
    v_and_b32 v38, v16, v34
    v_and_b32 v39, v16, v35
    v_and_b32 v40, v17, v32
    v_and_b32 v41, v17, v33
    v_and_b32 v42, v17, v34
    v_and_b32 v43, v17, v35
    v_mfma_f32_16x16x32_bf16 v[44:47], v[36:39], v[224:227], v[44:47]
    v_and_b32 v36, v18, v32
    v_and_b32 v37, v18, v33
    v_and_b32 v38, v18, v34
    v_and_b32 v39, v18, v35
    v_mfma_f32_16x16x32_bf16 v[44:47], v[40:43], v[228:231], v[44:47]
    v_and_b32 v40, v19, v32
    v_and_b32 v41, v19, v33
    v_and_b32 v42, v19, v34
    v_and_b32 v43, v19, v35
    v_mfma_f32_16x16x32_bf16 v[44:47], v[36:39], v[232:235], v[44:47]
    s_nop 0
    v_mfma_f32_16x16x32_bf16 v[44:47], v[40:43], v[236:239], v[44:47]
    s_mov_b32 exec_lo, 0x00ff00ff
    s_mov_b32 exec_hi, 0xff00ff00
    s_nop 5
    ds_write_b128 v10, v[44:47] offset:20480
    s_waitcnt lgkmcnt(0)
    s_mov_b64 exec, -1
    s_barrier
    v_mov_b32 v19, 16896
    ds_read_b32 v18, v19 offset:12
    s_waitcnt lgkmcnt(0)
    v_readfirstlane_b32 s63, v18
    s_sub_u32 s63, s63, 1
    s_cmp_lt_u32 s63, 28
    s_cbranch_scc1 L_sffn
L_exit:
    s_endpgm
L_sffn:
    v_lshrrev_b32 v30, 4, v1
    v_bfe_u32 v31, v1, 2, 2
    v_lshlrev_b32 v28, 9, v30
    v_lshl_add_u32 v28, v31, 11, v28
    v_and_b32 v30, 1, v30
    v_lshl_add_u32 v31, v30, 2, v31
    v_and_b32 v30, 2, v1
    v_lshl_add_u32 v31, v30, 2, v31
    v_add_u32 v31, s62, v31
    v_and_b32 v31, 15, v31
    v_lshl_add_u32 v28, v31, 4, v28
    v_and_b32 v30, 1, v1
    v_lshl_add_u32 v28, v30, 3, v28
    v_add_u32 v28, 40960, v28
    v_add_u32 v29, 0x10000, v28
    ds_read_b64_tr_b16 v[80:81], v28 offset:0
    ds_read_b64_tr_b16 v[82:83], v28 offset:256
    ds_read_b64_tr_b16 v[84:85], v28 offset:8192
    ds_read_b64_tr_b16 v[86:87], v28 offset:8448
    ds_read_b64_tr_b16 v[88:89], v28 offset:16384
    ds_read_b64_tr_b16 v[90:91], v28 offset:16640
    ds_read_b64_tr_b16 v[92:93], v28 offset:24576
    ds_read_b64_tr_b16 v[94:95], v28 offset:24832
    ds_read_b64_tr_b16 v[96:97], v28 offset:32768
    ds_read_b64_tr_b16 v[98:99], v28 offset:33024
    ds_read_b64_tr_b16 v[100:101], v28 offset:40960
    ds_read_b64_tr_b16 v[102:103], v28 offset:41216
    ds_read_b64_tr_b16 v[104:105], v28 offset:49152
    ds_read_b64_tr_b16 v[106:107], v28 offset:49408
    ds_read_b64_tr_b16 v[108:109], v28 offset:57344
    ds_read_b64_tr_b16 v[110:111], v28 offset:57600
    ds_read_b64_tr_b16 v[112:113], v29 offset:0
    ds_read_b64_tr_b16 v[114:115], v29 offset:256
    ds_read_b64_tr_b16 v[116:117], v29 offset:8192
    ds_read_b64_tr_b16 v[118:119], v29 offset:8448
    ds_read_b64_tr_b16 v[120:121], v29 offset:16384
    ds_read_b64_tr_b16 v[122:123], v29 offset:16640
    ds_read_b64_tr_b16 v[124:125], v29 offset:24576
    ds_read_b64_tr_b16 v[126:127], v29 offset:24832
    ds_read_b64_tr_b16 v[128:129], v29 offset:32768
    ds_read_b64_tr_b16 v[130:131], v29 offset:33024
    ds_read_b64_tr_b16 v[132:133], v29 offset:40960
    ds_read_b64_tr_b16 v[134:135], v29 offset:41216
    s_waitcnt lgkmcnt(0)
    s_barrier
    s_branch L_ffn
L_service:
    s_andn2_b32 s8, s2, 24
    s_mov_b32 s62, s3
    s_mov_b32 s12, s38
    s_mov_b32 s13, s39
    s_mov_b32 s14, 4194304
    s_mov_b32 s15, 0x20000
    s_sub_u32 s3, s3, 4
    s_mul_i32 s9, s3, 896
    s_add_u32 s40, s16, s9
    s_addc_u32 s41, s17, 0
    s_mov_b32 s42, 896
    s_mov_b32 s43, 0x20000
    v_lshrrev_b32 v5, 5, v1
    v_mul_u32_u24 v5, 14, v5
    v_and_b32 v6, 3, v1
    v_lshl_add_u32 v5, v6, 2, v5
    v_bfe_u32 v6, v1, 2, 2
    v_lshlrev_b32 v6, 1, v6
    v_bfe_u32 v7, v1, 4, 1
    v_add_u32 v6, v6, v7
    v_lshl_add_u32 v7, v5, 3, v6
    v_lshlrev_b32 v7, 1, v7
    buffer_load_ushort v8, v7, s[40:43], 0 offen offset:0
    buffer_load_ushort v9, v7, s[40:43], 0 offen offset:16
    buffer_load_ushort v10, v7, s[40:43], 0 offen offset:32
    buffer_load_ushort v11, v7, s[40:43], 0 offen offset:48
    buffer_load_ushort v12, v7, s[40:43], 0 offen offset:448
    buffer_load_ushort v13, v7, s[40:43], 0 offen offset:464
    buffer_load_ushort v14, v7, s[40:43], 0 offen offset:480
    buffer_load_ushort v15, v7, s[40:43], 0 offen offset:496
    v_mov_b32 v2, 0
    s_lshl_b32 s50, s6, 7
    buffer_load_dword v76, v2, s[12:15], s50 offen sc1
    s_lshl_b32 s9, s6, 9
    s_lshl_b32 s10, s4, 7
    s_add_u32 s9, s9, s10
    s_mul_i32 s10, s5, 917504
    s_add_u32 s9, s9, s10
    s_add_u32 s44, s22, s9
    s_addc_u32 s45, s23, 0
    s_mov_b32 s46, 909440
    s_mov_b32 s47, 0x20000
    v_lshlrev_b32 v16, 13, v3
    v_lshl_add_u32 v16, v4, 4, v16
    s_lshl_b32 s9, s3, 16
    v_add_u32 v16, s9, v16
    buffer_load_dwordx4 v[80:83], v16, s[44:47], 0 offen
    v_add_u32 v16, 262144, v16
    buffer_load_dwordx4 v[84:87], v16, s[44:47], 0 offen
    v_add_u32 v16, 262144, v16
    buffer_load_dwordx4 v[88:91], v16, s[44:47], 0 offen
    v_add_u32 v16, 262144, v16
    buffer_load_dwordx4 v[92:95], v16, s[44:47], 0 offen
    v_lshlrev_b32 v78, 8, v6
    v_lshrrev_b32 v5, 5, v1
    v_lshl_add_u32 v78, v5, 6, v78
    v_and_b32 v5, 3, v1
    v_lshl_add_u32 v78, v5, 4, v78
    s_lshl_b32 s10, s3, 11
    v_add_u32 v78, s10, v78
    s_lshl_b32 s9, s5, 6
    s_add_u32 s9, s9, s10
    v_lshlrev_b32 v79, 8, v3
    v_add_u32 v79, s9, v79
    v_mov_b32 v20, -1
    v_mov_b32 v21, -1
    v_mov_b32 v22, -1
    v_mov_b32 v23, -1
    v_mov_b32 v24, 0
    v_mov_b32 v25, 0
    v_mov_b32 v26, 0
    v_mov_b32 v27, 0
    v_lshlrev_b32 v17, 4, v1
    s_cmp_eq_u32 s3, 0
    s_cbranch_scc0 L_f1
    s_lshl_b32 s9, s7, 13
    s_lshl_b32 s10, s4, 11
    s_add_u32 s9, s9, s10
    s_add_u32 s9, s9, 262144
    buffer_store_dwordx4 v[20:23], v17, s[12:15], s9 offen sc1
    buffer_store_dwordx4 v[20:23], v17, s[12:15], s9 offen offset:1024 sc1
    s_branch L_f3
L_f1:
    s_cmp_eq_u32 s3, 1
    s_cbranch_scc0 L_f2
    s_lshl_b32 s9, s2, 10
    s_add_u32 s9, s9, 2097152
    buffer_store_dwordx4 v[20:23], v17, s[12:15], s9 offen sc1
    s_branch L_f3
L_f2:
    s_cmp_eq_u32 s3, 2
    s_cbranch_scc0 L_f3
    s_cmp_eq_u32 s8, 0
    s_cbranch_scc0 L_f3
    s_lshl_b32 s9, s5, 12
    s_add_u32 s9, s9, 1048576
    buffer_store_dwordx4 v[24:27], v17, s[12:15], s9 offen offset:0 sc1
    buffer_store_dwordx4 v[24:27], v17, s[12:15], s9 offen offset:1024 sc1
    buffer_store_dwordx4 v[24:27], v17, s[12:15], s9 offen offset:2048 sc1
L_f3:
    v_and_b32 v16, 1, v1
    v_cmp_eq_u32 vcc, 1, v16
    v_mov_b32 v18, 0xffff
    v_mov_b32 v19, 0xffff0000
    v_cndmask_b32 v18, v18, v19, vcc
    v_lshrrev_b32 v16, 1, v4
    v_cmp_eq_u32 vcc, 0, v16
    s_nop 1
    v_cndmask_b32 v56, 0, v18, vcc
    v_cmp_eq_u32 vcc, 1, v16
    s_nop 1
    v_cndmask_b32 v57, 0, v18, vcc
    v_cmp_eq_u32 vcc, 2, v16
    s_nop 1
    v_cndmask_b32 v58, 0, v18, vcc
    v_cmp_eq_u32 vcc, 3, v16
    s_nop 1
    v_cndmask_b32 v59, 0, v18, vcc
    v_bfe_u32 v16, v1, 1, 3
    v_cmp_eq_u32 vcc, 0, v16
    s_nop 1
    v_cndmask_b32 v60, 0, v18, vcc
    v_cmp_eq_u32 vcc, 2, v16
    s_nop 1
    v_cndmask_b32 v61, 0, v18, vcc
    v_cmp_eq_u32 vcc, 4, v16
    s_nop 1
    v_cndmask_b32 v62, 0, v18, vcc
    v_cmp_eq_u32 vcc, 6, v16
    s_nop 1
    v_cndmask_b32 v63, 0, v18, vcc
    s_mov_b32 s52, 0x77777777
    s_mov_b32 s53, 0x77777777
    s_waitcnt vmcnt(5)
    v_lshlrev_b32 v8, 16, v8
    v_lshlrev_b32 v9, 16, v9
    v_lshlrev_b32 v10, 16, v10
    v_lshlrev_b32 v11, 16, v11
    v_lshlrev_b32 v12, 16, v12
    v_lshlrev_b32 v13, 16, v13
    v_lshlrev_b32 v14, 16, v14
    v_lshlrev_b32 v15, 16, v15
    v_cndmask_b32 v10, 0, v10, s[52:53]
    v_cndmask_b32 v11, 0, v11, s[52:53]
    v_cndmask_b32 v14, 0, v14, s[52:53]
    v_cndmask_b32 v15, 0, v15, s[52:53]
    v_add_f32 v16, v8, v9
    v_add_f32 v17, v10, v11
    v_add_f32 v18, v12, v13
    v_add_f32 v19, v14, v15
    v_add_f32 v16, v16, v17
    v_add_f32 v18, v18, v19
    v_add_f32 v16, v16, v18
    s_nop 1
    v_add_f32_dpp v16, v16, v16 quad_perm:[1,0,3,2] row_mask:0xf bank_mask:0xf
    s_nop 1
    v_add_f32_dpp v16, v16, v16 quad_perm:[2,3,0,1] row_mask:0xf bank_mask:0xf
    s_nop 1
    v_add_f32_dpp v16, v16, v16 row_half_mirror row_mask:0xf bank_mask:0xf
    s_nop 1
    v_add_f32_dpp v16, v16, v16 row_mirror row_mask:0xf bank_mask:0xf
    s_nop 0
    v_readlane_b32 s56, v16, 0
    v_readlane_b32 s57, v16, 16
    v_readlane_b32 s58, v16, 32
    v_readlane_b32 s59, v16, 48
    v_mov_b32 v16, s56
    v_add_f32 v16, s57, v16
    v_add_f32 v16, s58, v16
    v_add_f32 v16, s59, v16
    v_mul_f32 v16, 2.2321428571e-03, v16
    v_sub_f32 v20, v8, v16
    v_sub_f32 v21, v9, v16
    v_sub_f32 v22, v10, v16
    v_sub_f32 v23, v11, v16
    v_sub_f32 v24, v12, v16
    v_sub_f32 v25, v13, v16
    v_sub_f32 v26, v14, v16
    v_sub_f32 v27, v15, v16
    v_cndmask_b32 v22, 0, v22, s[52:53]
    v_cndmask_b32 v23, 0, v23, s[52:53]
    v_cndmask_b32 v26, 0, v26, s[52:53]
    v_cndmask_b32 v27, 0, v27, s[52:53]
    v_mul_f32 v17, v20, v20
    v_mul_f32 v18, v21, v21
    v_fmac_f32 v17, v22, v22
    v_fmac_f32 v18, v23, v23
    v_fmac_f32 v17, v24, v24
    v_fmac_f32 v18, v25, v25
    v_fmac_f32 v17, v26, v26
    v_fmac_f32 v18, v27, v27
    v_add_f32 v17, v17, v18
    v_cvt_pk_bf16_f32 v16, v16, v16
    v_and_b32 v16, 0xffff0000, v16
    v_add_f32_dpp v17, v17, v17 quad_perm:[1,0,3,2] row_mask:0xf bank_mask:0xf
    s_nop 1
    v_add_f32_dpp v17, v17, v17 quad_perm:[2,3,0,1] row_mask:0xf bank_mask:0xf
    s_nop 1
    v_add_f32_dpp v17, v17, v17 row_half_mirror row_mask:0xf bank_mask:0xf
    s_nop 1
    v_add_f32_dpp v17, v17, v17 row_mirror row_mask:0xf bank_mask:0xf
    s_nop 0
    v_readlane_b32 s56, v17, 0
    v_readlane_b32 s57, v17, 16
    v_readlane_b32 s58, v17, 32
    v_readlane_b32 s59, v17, 48
    v_mov_b32 v17, s56
    v_add_f32 v17, s57, v17
    v_add_f32 v17, s58, v17
    v_add_f32 v17, s59, v17
    v_sub_f32 v20, v8, v16
    v_sub_f32 v21, v9, v16
    v_sub_f32 v22, v10, v16
    v_sub_f32 v23, v11, v16
    v_sub_f32 v24, v12, v16
    v_sub_f32 v25, v13, v16
    v_sub_f32 v26, v14, v16
    v_sub_f32 v27, v15, v16
    v_mul_f32 v17, 2.2321428571e-03, v17
    v_cvt_pk_bf16_f32 v17, v17, v17
    v_and_b32 v17, 0xffff0000, v17
    v_add_f32 v17, 0x3727c5ac, v17
    v_cvt_pk_bf16_f32 v17, v17, v17
    v_and_b32 v17, 0xffff0000, v17
    v_sqrt_f32 v17, v17
    v_cvt_pk_bf16_f32 v20, v20, v20
    v_and_b32 v20, 0xffff0000, v20
    v_cvt_pk_bf16_f32 v21, v21, v21
    v_and_b32 v21, 0xffff0000, v21
    v_cvt_pk_bf16_f32 v22, v22, v22
    v_and_b32 v22, 0xffff0000, v22
    v_cvt_pk_bf16_f32 v23, v23, v23
    v_and_b32 v23, 0xffff0000, v23
    v_cvt_pk_bf16_f32 v24, v24, v24
    v_and_b32 v24, 0xffff0000, v24
    v_cvt_pk_bf16_f32 v25, v25, v25
    v_and_b32 v25, 0xffff0000, v25
    v_cvt_pk_bf16_f32 v26, v26, v26
    v_and_b32 v26, 0xffff0000, v26
    v_cvt_pk_bf16_f32 v27, v27, v27
    v_and_b32 v27, 0xffff0000, v27
    v_cvt_pk_bf16_f32 v17, v17, v17
    v_and_b32 v17, 0xffff0000, v17
    v_rcp_f32 v17, v17
    s_nop 0
    v_mul_f32 v20, v20, v17
    v_mul_f32 v21, v21, v17
    v_mul_f32 v22, v22, v17
    v_mul_f32 v23, v23, v17
    v_mul_f32 v24, v24, v17
    v_mul_f32 v25, v25, v17
    v_mul_f32 v26, v26, v17
    v_mul_f32 v27, v27, v17
    v_cvt_pk_bf16_f32 v20, v20, v20
    v_cvt_pk_bf16_f32 v21, v21, v21
    v_cvt_pk_bf16_f32 v22, v22, v22
    v_cvt_pk_bf16_f32 v23, v23, v23
    v_cvt_pk_bf16_f32 v24, v24, v24
    v_cvt_pk_bf16_f32 v25, v25, v25
    v_cvt_pk_bf16_f32 v26, v26, v26
    v_cvt_pk_bf16_f32 v27, v27, v27
    ds_write_b128 v78, v[20:23] offset:0
    ds_write_b128 v78, v[24:27] offset:128
    s_waitcnt lgkmcnt(0)
    ds_read_b128 v[40:43], v79 offset:0
    ds_read_b128 v[44:47], v79 offset:16
    ds_read_b128 v[48:51], v79 offset:32
    ds_read_b128 v[52:55], v79 offset:48
    v_bfe_u32 v6, v1, 4, 1
    v_lshlrev_b32 v6, 4, v6
    v_lshl_add_u32 v6, v4, 5, v6
    v_lshrrev_b32 v5, 5, v1
    v_lshl_add_u32 v5, v5, 8, v6
    s_lshl_b32 s9, s3, 9
    v_add_u32 v5, s9, v5
    v_lshlrev_b32 v17, 4, v1
    s_lshl_b32 s9, s3, 10
    v_add_u32 v18, s9, v17
    v_mov_b32 v19, 16896
    v_mov_b32 v20, 1
    s_mov_b32 s54, 1600000
    s_waitcnt vmcnt(0)
    ds_write_b128 v18, v[80:83] offset:40960
    ds_write_b128 v18, v[84:87] offset:45056
    ds_write_b128 v18, v[88:91] offset:49152
    ds_write_b128 v18, v[92:95] offset:53248
    s_waitcnt lgkmcnt(0)
    s_mov_b64 exec, 1
    ds_add_u32 v19, v20
    s_mov_b64 exec, -1
L_pollw:
    ds_read_b32 v16, v19
    s_waitcnt lgkmcnt(0)
    v_readfirstlane_b32 s10, v16
    s_cmp_eq_u32 s10, 4
    s_cbranch_scc1 L_gotw
    s_sleep 1
    s_sub_u32 s54, s54, 1
    s_cmp_lg_u32 s54, 0
    s_cbranch_scc1 L_pollw
L_gotw:
    ds_read_b128 v[80:83], v17 offset:40960
    ds_read_b128 v[84:87], v17 offset:41984
    ds_read_b128 v[88:91], v17 offset:43008
    ds_read_b128 v[92:95], v17 offset:44032
    ds_read_b128 v[96:99], v17 offset:45056
    ds_read_b128 v[100:103], v17 offset:46080
    ds_read_b128 v[104:107], v17 offset:47104
    ds_read_b128 v[108:111], v17 offset:48128
    ds_read_b128 v[112:115], v17 offset:49152
    ds_read_b128 v[116:119], v17 offset:50176
    ds_read_b128 v[120:123], v17 offset:51200
    ds_read_b128 v[124:127], v17 offset:52224
    ds_read_b128 v[128:131], v17 offset:53248
    ds_read_b128 v[132:135], v17 offset:54272
    v_add_u32 v76, 0x9e3779b9, v76
    v_lshlrev_b32 v18, 3, v1
    s_lshl_b32 s9, s6, 15
    s_add_u32 s9, s9, 1572864
    s_lshl_b32 s51, s5, 13
    s_add_u32 s51, s51, s9
    s_lshl_b32 s10, s3, 11
    s_add_u32 s51, s51, s10
    s_lshl_b32 s10, s3, 13
    s_add_u32 s9, s9, s10
    s_lshl_b32 s10, s4, 11
    s_add_u32 s9, s9, s10
    s_lshl_b32 s10, s5, 9
    s_add_u32 s9, s9, s10
    v_lshlrev_b32 v16, 2, v1
    s_lshl_b32 s10, s3, 9
    v_add_u32 v16, s10, v16
    v_mov_b32 v72, 0
    v_mov_b32 v73, 0
    v_mov_b32 v74, 0
    v_mov_b32 v75, 0
    v_and_b32 v64, v40, v56
    v_and_b32 v65, v40, v57
    v_and_b32 v66, v40, v58
    v_and_b32 v67, v40, v59
    v_and_b32 v68, v41, v56
    v_and_b32 v69, v41, v57
    v_and_b32 v70, v41, v58
    v_and_b32 v71, v41, v59
    s_waitcnt lgkmcnt(13)
    v_mfma_f32_16x16x32_bf16 v[72:75], v[64:67], v[80:83], v[72:75]
    v_and_b32 v64, v42, v56
    v_and_b32 v65, v42, v57
    v_and_b32 v66, v42, v58
    v_and_b32 v67, v42, v59
    s_waitcnt lgkmcnt(12)
    v_mfma_f32_16x16x32_bf16 v[72:75], v[68:71], v[84:87], v[72:75]
    v_and_b32 v68, v43, v56
    v_and_b32 v69, v43, v57
    v_and_b32 v70, v43, v58
    v_and_b32 v71, v43, v59
    s_waitcnt lgkmcnt(11)
    v_mfma_f32_16x16x32_bf16 v[72:75], v[64:67], v[88:91], v[72:75]
    v_and_b32 v64, v44, v56
    v_and_b32 v65, v44, v57
    v_and_b32 v66, v44, v58
    v_and_b32 v67, v44, v59
    s_waitcnt lgkmcnt(10)
    v_mfma_f32_16x16x32_bf16 v[72:75], v[68:71], v[92:95], v[72:75]
    v_and_b32 v68, v45, v56
    v_and_b32 v69, v45, v57
    v_and_b32 v70, v45, v58
    v_and_b32 v71, v45, v59
    s_waitcnt lgkmcnt(9)
    v_mfma_f32_16x16x32_bf16 v[72:75], v[64:67], v[96:99], v[72:75]
    v_and_b32 v64, v46, v56
    v_and_b32 v65, v46, v57
    v_and_b32 v66, v46, v58
    v_and_b32 v67, v46, v59
    s_waitcnt lgkmcnt(8)
    v_mfma_f32_16x16x32_bf16 v[72:75], v[68:71], v[100:103], v[72:75]
    v_and_b32 v68, v47, v56
    v_and_b32 v69, v47, v57
    v_and_b32 v70, v47, v58
    v_and_b32 v71, v47, v59
    s_waitcnt lgkmcnt(7)
    v_mfma_f32_16x16x32_bf16 v[72:75], v[64:67], v[104:107], v[72:75]
    v_and_b32 v64, v48, v56
    v_and_b32 v65, v48, v57
    v_and_b32 v66, v48, v58
    v_and_b32 v67, v48, v59
    s_waitcnt lgkmcnt(6)
    v_mfma_f32_16x16x32_bf16 v[72:75], v[68:71], v[108:111], v[72:75]
    v_and_b32 v68, v49, v56
    v_and_b32 v69, v49, v57
    v_and_b32 v70, v49, v58
    v_and_b32 v71, v49, v59
    s_waitcnt lgkmcnt(5)
    v_mfma_f32_16x16x32_bf16 v[72:75], v[64:67], v[112:115], v[72:75]
    v_and_b32 v64, v50, v56
    v_and_b32 v65, v50, v57
    v_and_b32 v66, v50, v58
    v_and_b32 v67, v50, v59
    s_waitcnt lgkmcnt(4)
    v_mfma_f32_16x16x32_bf16 v[72:75], v[68:71], v[116:119], v[72:75]
    v_and_b32 v68, v51, v56
    v_and_b32 v69, v51, v57
    v_and_b32 v70, v51, v58
    v_and_b32 v71, v51, v59
    s_waitcnt lgkmcnt(3)
    v_mfma_f32_16x16x32_bf16 v[72:75], v[64:67], v[120:123], v[72:75]
    v_and_b32 v64, v52, v56
    v_and_b32 v65, v52, v57
    v_and_b32 v66, v52, v58
    v_and_b32 v67, v52, v59
    s_waitcnt lgkmcnt(2)
    v_mfma_f32_16x16x32_bf16 v[72:75], v[68:71], v[124:127], v[72:75]
    v_and_b32 v68, v53, v56
    v_and_b32 v69, v53, v57
    v_and_b32 v70, v53, v58
    v_and_b32 v71, v53, v59
    s_waitcnt lgkmcnt(1)
    v_mfma_f32_16x16x32_bf16 v[72:75], v[64:67], v[128:131], v[72:75]
    s_waitcnt lgkmcnt(0)
    v_mfma_f32_16x16x32_bf16 v[72:75], v[68:71], v[132:135], v[72:75]
    s_mov_b32 exec_lo, 0x00ff00ff
    s_mov_b32 exec_hi, 0xff00ff00
    s_nop 5
    ds_write_b128 v5, v[72:75] offset:20480
    s_mov_b64 exec, -1
    ds_read2st64_b32 v[20:21], v16 offset0:80 offset1:81
    s_waitcnt lgkmcnt(0)
    v_add_f32 v20, v20, v21
    v_mov_b32 v21, v76
    buffer_store_dwordx2 v[20:21], v18, s[12:15], s9 offen sc1
    s_cmp_eq_u32 s3, 2
    s_cbranch_scc0 L_noflag
    s_cmp_eq_u32 s8, 0
    s_cbranch_scc0 L_noflag
    s_mov_b32 s40, s36
    s_mov_b32 s41, s37
    s_mov_b32 s42, 256
    s_mov_b32 s43, 0x20000
    s_lshl_b32 s9, s5, 6
    v_mov_b32 v22, 1
    s_mov_b64 exec, 1
    buffer_store_dword v22, v2, s[40:43], s9 offen sc1
    s_mov_b64 exec, -1
L_noflag:
    s_mov_b32 s54, 200000
L_pollq:
    buffer_load_dwordx2 v[20:21], v18, s[12:15], s51 offen offset:0 sc1
    buffer_load_dwordx2 v[22:23], v18, s[12:15], s51 offen offset:512 sc1
    buffer_load_dwordx2 v[24:25], v18, s[12:15], s51 offen offset:1024 sc1
    buffer_load_dwordx2 v[26:27], v18, s[12:15], s51 offen offset:1536 sc1
    s_waitcnt vmcnt(0)
    v_xor_b32 v21, v21, v76
    v_xor_b32 v23, v23, v76
    v_xor_b32 v25, v25, v76
    v_xor_b32 v27, v27, v76
    v_or_b32 v21, v21, v23
    v_or3_b32 v21, v21, v25, v27
    v_cmp_eq_u32 vcc, 0, v21
    s_cmp_eq_u64 vcc, -1
    s_cbranch_scc1 L_gotq
    s_sleep 1
    s_sub_u32 s54, s54, 1
    s_cmp_lg_u32 s54, 0
    s_cbranch_scc1 L_pollq
L_gotq:
    v_add_f32 v20, v20, v22
    v_add_f32 v24, v24, v26
    v_add_f32 v20, v20, v24
    v_cvt_pk_bf16_f32 v20, v20, v20
    v_lshlrev_b32 v16, 1, v1
    s_lshl_b32 s9, s3, 7
    v_add_u32 v16, s9, v16
    ds_write_b16 v16, v20 offset:16384
    s_waitcnt lgkmcnt(0)
    s_barrier
    s_lshl_b32 s9, s6, 2
    s_add_u32 s9, s9, s4
    s_mul_i32 s9, s9, 57344
    s_lshl_b32 s10, s3, 8
    s_add_u32 s9, s9, s10
    s_sub_u32 s10, 3670016, s9
    s_add_u32 s40, s24, s9
    s_addc_u32 s41, s25, 0
    s_mov_b32 s42, s10
    s_mov_b32 s43, 0x20000
    v_lshrrev_b32 v24, 4, v1
    v_mul_u32_u24 v24, 896, v24
    v_and_b32 v25, 15, v1
    v_lshl_add_u32 v24, v25, 4, v24
    s_cmp_eq_u32 s3, 3
    s_cselect_b32 s60, 0x00ff00ff, -1
    s_mov_b32 s61, s60
    s_mov_b64 exec, s[60:61]
    s_mov_b32 s48, 0
    s_waitcnt vmcnt(63)
    buffer_load_dwordx4 v[136:139], v24, s[40:43], s48 offen
    s_mov_b32 s48, 3584
    s_waitcnt vmcnt(63)
    buffer_load_dwordx4 v[140:143], v24, s[40:43], s48 offen
    s_mov_b32 s48, 7168
    s_waitcnt vmcnt(63)
    buffer_load_dwordx4 v[144:147], v24, s[40:43], s48 offen
    s_mov_b32 s48, 10752
    s_waitcnt vmcnt(63)
    buffer_load_dwordx4 v[148:151], v24, s[40:43], s48 offen
    s_mov_b32 s48, 14336
    s_waitcnt vmcnt(63)
    buffer_load_dwordx4 v[152:155], v24, s[40:43], s48 offen
    s_mov_b32 s48, 17920
    s_waitcnt vmcnt(63)
    buffer_load_dwordx4 v[156:159], v24, s[40:43], s48 offen
    s_mov_b32 s48, 21504
    s_waitcnt vmcnt(63)
    buffer_load_dwordx4 v[160:163], v24, s[40:43], s48 offen
    s_mov_b32 s48, 25088
    s_waitcnt vmcnt(63)
    buffer_load_dwordx4 v[164:167], v24, s[40:43], s48 offen
    s_mov_b32 s48, 28672
    s_waitcnt vmcnt(63)
    buffer_load_dwordx4 v[168:171], v24, s[40:43], s48 offen
    s_mov_b32 s48, 32256
    s_waitcnt vmcnt(63)
    buffer_load_dwordx4 v[172:175], v24, s[40:43], s48 offen
    s_mov_b32 s48, 35840
    s_waitcnt vmcnt(63)
    buffer_load_dwordx4 v[176:179], v24, s[40:43], s48 offen
    s_mov_b32 s48, 39424
    s_waitcnt vmcnt(63)
    buffer_load_dwordx4 v[180:183], v24, s[40:43], s48 offen
    s_mov_b32 s48, 43008
    s_waitcnt vmcnt(63)
    buffer_load_dwordx4 v[184:187], v24, s[40:43], s48 offen
    s_mov_b32 s48, 46592
    s_waitcnt vmcnt(63)
    buffer_load_dwordx4 v[188:191], v24, s[40:43], s48 offen
    s_mov_b32 s48, 50176
    s_waitcnt vmcnt(63)
    buffer_load_dwordx4 v[192:195], v24, s[40:43], s48 offen
    s_mov_b32 s48, 53760
    s_waitcnt vmcnt(63)
    buffer_load_dwordx4 v[196:199], v24, s[40:43], s48 offen
    s_mov_b64 exec, -1
    s_or_b32 s9, s3, s4
    s_or_b32 s9, s9, s5
    s_cmp_eq_u32 s9, 0
    s_cbranch_scc0 L_nobump
    s_mov_b64 exec, 1
    buffer_store_dword v76, v2, s[12:15], s50 offen sc1
    s_mov_b64 exec, -1
L_nobump:
    s_mov_b32 s40, s36
    s_mov_b32 s41, s37
    s_mov_b32 s42, 256
    s_mov_b32 s43, 0x20000
    v_and_b32 v17, 3, v1
    v_lshlrev_b32 v17, 6, v17
    s_mov_b32 s54, 200000
L_pollz:
    buffer_load_dword v16, v17, s[40:43], 0 offen sc1
    s_waitcnt vmcnt(0)
    v_cmp_eq_u32 vcc, 1, v16
    s_cmp_eq_u64 vcc, -1
    s_cbranch_scc1 L_gotz
    s_sleep 8
    s_sub_u32 s54, s54, 1
    s_cmp_lg_u32 s54, 0
    s_cbranch_scc1 L_pollz
L_gotz:
    v_mov_b32 v17, 16896
    s_mov_b32 s54, 1600000
L_pollk:
    ds_read_b32 v16, v17 offset:4
    s_waitcnt lgkmcnt(0)
    v_readfirstlane_b32 s10, v16
    s_cmp_eq_u32 s10, 4
    s_cbranch_scc1 L_gotk
    s_sleep 2
    s_sub_u32 s54, s54, 1
    s_cmp_lg_u32 s54, 0
    s_cbranch_scc1 L_pollk
L_gotk:
    s_lshl_b32 s9, s7, 13
    s_lshl_b32 s10, s3, 11
    s_add_u32 s9, s9, s10
    s_add_u32 s9, s9, 262144
    v_lshlrev_b32 v17, 4, v1
    s_mov_b32 s54, 200000
L_polls:
    buffer_load_dwordx4 v[24:27], v17, s[12:15], s9 offen sc1
    buffer_load_dwordx4 v[28:31], v17, s[12:15], s9 offen offset:1024 sc1
    s_waitcnt vmcnt(0)
    v_max_u32 v16, v24, v25
    v_max3_u32 v16, v16, v26, v27
    v_max3_u32 v16, v16, v28, v29
    v_max3_u32 v16, v16, v30, v31
    v_cmp_eq_u32 vcc, -1, v16
    s_cmp_eq_u64 vcc, 0
    s_cbranch_scc1 L_gots
    s_sleep 2
    s_sub_u32 s54, s54, 1
    s_cmp_lg_u32 s54, 0
    s_cbranch_scc1 L_polls
L_gots:
    v_lshlrev_b32 v40, 16, v24
    v_and_b32 v48, 0xffff0000, v24
    v_lshlrev_b32 v41, 16, v25
    v_and_b32 v49, 0xffff0000, v25
    v_lshlrev_b32 v42, 16, v26
    v_and_b32 v50, 0xffff0000, v26
    v_lshlrev_b32 v43, 16, v27
    v_and_b32 v51, 0xffff0000, v27
    v_lshlrev_b32 v44, 16, v28
    v_and_b32 v52, 0xffff0000, v28
    v_lshlrev_b32 v45, 16, v29
    v_and_b32 v53, 0xffff0000, v29
    v_lshlrev_b32 v46, 16, v30
    v_and_b32 v54, 0xffff0000, v30
    v_lshlrev_b32 v47, 16, v31
    v_and_b32 v55, 0xffff0000, v31
    v_max_f32 v16, v40, v41
    v_max3_f32 v16, v16, v42, v43
    v_max3_f32 v16, v16, v44, v45
    v_max3_f32 v16, v16, v46, v47
    v_max3_f32 v16, v16, v48, v49
    v_max3_f32 v16, v16, v50, v51
    v_max3_f32 v16, v16, v52, v53
    v_max3_f32 v16, v16, v54, v55
    s_nop 1
    v_max_f32_dpp v16, v16, v16 quad_perm:[1,0,3,2] row_mask:0xf bank_mask:0xf
    s_nop 1
    v_max_f32_dpp v16, v16, v16 quad_perm:[2,3,0,1] row_mask:0xf bank_mask:0xf
    s_nop 1
    v_max_f32_dpp v16, v16, v16 row_half_mirror row_mask:0xf bank_mask:0xf
    s_nop 1
    v_max_f32_dpp v16, v16, v16 row_mirror row_mask:0xf bank_mask:0xf
    s_nop 0
    v_readlane_b32 s56, v16, 0
    v_readlane_b32 s57, v16, 16
    v_readlane_b32 s58, v16, 32
    v_readlane_b32 s59, v16, 48
    v_mov_b32 v16, s56
    v_max_f32 v16, s57, v16
    v_max_f32 v16, s58, v16
    v_max_f32 v16, s59, v16
    s_mov_b32 s55, 0x3db8aa3b
    v_sub_f32 v40, v40, v16
    v_sub_f32 v41, v41, v16
    v_sub_f32 v42, v42, v16
    v_sub_f32 v43, v43, v16
    v_sub_f32 v44, v44, v16
    v_sub_f32 v45, v45, v16
    v_sub_f32 v46, v46, v16
    v_sub_f32 v47, v47, v16
    v_sub_f32 v48, v48, v16
    v_sub_f32 v49, v49, v16
    v_sub_f32 v50, v50, v16
    v_sub_f32 v51, v51, v16
    v_sub_f32 v52, v52, v16
    v_sub_f32 v53, v53, v16
    v_sub_f32 v54, v54, v16
    v_sub_f32 v55, v55, v16
    v_mul_f32 v40, s55, v40
    v_mul_f32 v41, s55, v41
    v_mul_f32 v42, s55, v42
    v_mul_f32 v43, s55, v43
    v_mul_f32 v44, s55, v44
    v_mul_f32 v45, s55, v45
    v_mul_f32 v46, s55, v46
    v_mul_f32 v47, s55, v47
    v_mul_f32 v48, s55, v48
    v_mul_f32 v49, s55, v49
    v_mul_f32 v50, s55, v50
    v_mul_f32 v51, s55, v51
    v_mul_f32 v52, s55, v52
    v_mul_f32 v53, s55, v53
    v_mul_f32 v54, s55, v54
    v_mul_f32 v55, s55, v55
    v_exp_f32 v40, v40
    v_exp_f32 v41, v41
    v_exp_f32 v42, v42
    v_exp_f32 v43, v43
    v_exp_f32 v44, v44
    v_exp_f32 v45, v45
    v_exp_f32 v46, v46
    v_exp_f32 v47, v47
    v_exp_f32 v48, v48
    v_exp_f32 v49, v49
    v_exp_f32 v50, v50
    v_exp_f32 v51, v51
    v_exp_f32 v52, v52
    v_exp_f32 v53, v53
    v_exp_f32 v54, v54
    v_exp_f32 v55, v55
    v_add_f32 v17, v40, v41
    v_add_f32 v18, v42, v43
    v_add_f32 v17, v17, v44
    v_add_f32 v18, v18, v45
    v_add_f32 v17, v17, v46
    v_add_f32 v18, v18, v47
    v_add_f32 v17, v17, v48
    v_add_f32 v18, v18, v49
    v_add_f32 v17, v17, v50
    v_add_f32 v18, v18, v51
    v_add_f32 v17, v17, v52
    v_add_f32 v18, v18, v53
    v_add_f32 v17, v17, v54
    v_add_f32 v18, v18, v55
    v_add_f32 v17, v17, v18
    s_nop 1
    v_add_f32_dpp v17, v17, v17 quad_perm:[1,0,3,2] row_mask:0xf bank_mask:0xf
    s_nop 1
    v_add_f32_dpp v17, v17, v17 quad_perm:[2,3,0,1] row_mask:0xf bank_mask:0xf
    s_nop 1
    v_add_f32_dpp v17, v17, v17 row_half_mirror row_mask:0xf bank_mask:0xf
    s_nop 1
    v_add_f32_dpp v17, v17, v17 row_mirror row_mask:0xf bank_mask:0xf
    s_nop 0
    v_readlane_b32 s56, v17, 0
    v_readlane_b32 s57, v17, 16
    v_readlane_b32 s58, v17, 32
    v_readlane_b32 s59, v17, 48
    v_mov_b32 v17, s56
    v_add_f32 v17, s57, v17
    v_add_f32 v17, s58, v17
    v_add_f32 v17, s59, v17
    s_lshl_b32 s9, s3, 3
    v_mov_b32 v18, s9
    s_mov_b64 exec, 1
    ds_write_b64 v18, v[16:17] offset:16912
    v_mov_b32 v18, 16896
    v_mov_b32 v19, 1
    s_waitcnt lgkmcnt(0)
    ds_add_u32 v18, v19 offset:8
    s_mov_b64 exec, -1
    v_mov_b32 v18, 16896
    s_mov_b32 s54, 1600000
L_pollm:
    ds_read_b32 v19, v18 offset:8
    s_waitcnt lgkmcnt(0)
    v_readfirstlane_b32 s10, v19
    s_cmp_eq_u32 s10, 4
    s_cbranch_scc1 L_gotm
    s_sleep 1
    s_sub_u32 s54, s54, 1
    s_cmp_lg_u32 s54, 0
    s_cbranch_scc1 L_pollm
L_gotm:
    ds_read_b128 v[24:27], v18 offset:16
    ds_read_b128 v[28:31], v18 offset:32
    s_waitcnt lgkmcnt(0)
    v_max_f32 v19, v24, v26
    v_max3_f32 v19, v19, v28, v30
    v_sub_f32 v24, v24, v19
    v_sub_f32 v26, v26, v19
    v_sub_f32 v28, v28, v19
    v_sub_f32 v30, v30, v19
    v_sub_f32 v16, v16, v19
    v_mul_f32 v24, s55, v24
    v_mul_f32 v26, s55, v26
    v_mul_f32 v28, s55, v28
    v_mul_f32 v30, s55, v30
    v_mul_f32 v16, s55, v16
    v_exp_f32 v24, v24
    v_exp_f32 v26, v26
    v_exp_f32 v28, v28
    v_exp_f32 v30, v30
    v_exp_f32 v16, v16
    v_mul_f32 v17, v24, v25
    v_fmac_f32 v17, v26, v27
    v_fmac_f32 v17, v28, v29
    v_fmac_f32 v17, v30, v31
    v_rcp_f32 v17, v17
    s_nop 0
    v_mul_f32 v16, v16, v17
    v_bfe_u32 v18, v1, 4, 1
    v_lshlrev_b32 v18, 11, v18
    v_and_b32 v19, 1, v1
    v_lshl_add_u32 v18, v19, 9, v18
    v_bfe_u32 v19, v1, 1, 3
    v_lshl_add_u32 v18, v19, 4, v18
    v_lshrrev_b32 v19, 5, v1
    v_lshl_add_u32 v18, v19, 2, v18
    s_lshl_b32 s9, s3, 12
    v_add_u32 v18, s9, v18
    v_mul_f32 v40, v40, v16
    v_mul_f32 v41, v41, v16
    v_mul_f32 v42, v42, v16
    v_mul_f32 v43, v43, v16
    v_mul_f32 v44, v44, v16
    v_mul_f32 v45, v45, v16
    v_mul_f32 v46, v46, v16
    v_mul_f32 v47, v47, v16
    v_mul_f32 v48, v48, v16
    v_mul_f32 v49, v49, v16
    v_mul_f32 v50, v50, v16
    v_mul_f32 v51, v51, v16
    v_mul_f32 v52, v52, v16
    v_mul_f32 v53, v53, v16
    v_mul_f32 v54, v54, v16
    v_mul_f32 v55, v55, v16
    v_cvt_pk_bf16_f32 v40, v40, v40
    v_cvt_pk_bf16_f32 v41, v41, v41
    v_cvt_pk_bf16_f32 v42, v42, v42
    v_cvt_pk_bf16_f32 v43, v43, v43
    v_cvt_pk_bf16_f32 v44, v44, v44
    v_cvt_pk_bf16_f32 v45, v45, v45
    v_cvt_pk_bf16_f32 v46, v46, v46
    v_cvt_pk_bf16_f32 v47, v47, v47
    v_cvt_pk_bf16_f32 v48, v48, v48
    v_cvt_pk_bf16_f32 v49, v49, v49
    v_cvt_pk_bf16_f32 v50, v50, v50
    v_cvt_pk_bf16_f32 v51, v51, v51
    v_cvt_pk_bf16_f32 v52, v52, v52
    v_cvt_pk_bf16_f32 v53, v53, v53
    v_cvt_pk_bf16_f32 v54, v54, v54
    v_cvt_pk_bf16_f32 v55, v55, v55
    ds_write_b32 v18, v40 offset:0
    ds_write_b32 v18, v41 offset:128
    ds_write_b32 v18, v42 offset:256
    ds_write_b32 v18, v43 offset:384
    ds_write_b32 v18, v44 offset:8
    ds_write_b32 v18, v45 offset:136
    ds_write_b32 v18, v46 offset:264
    ds_write_b32 v18, v47 offset:392
    ds_write_b32 v18, v48 offset:1024
    ds_write_b32 v18, v49 offset:1152
    ds_write_b32 v18, v50 offset:1280
    ds_write_b32 v18, v51 offset:1408
    ds_write_b32 v18, v52 offset:1032
    ds_write_b32 v18, v53 offset:1160
    ds_write_b32 v18, v54 offset:1288
    ds_write_b32 v18, v55 offset:1416
    s_waitcnt lgkmcnt(0)
    s_barrier
    v_mov_b32 v17, 16896
    s_cmp_eq_u32 s3, 0
    s_cbranch_scc0 L_waitrole
    s_mov_b32 s40, s36
    s_mov_b32 s41, s37
    s_mov_b32 s42, 256
    s_mov_b32 s43, 0x20000
    s_mov_b64 exec, 1
    v_mov_b32 v16, 1
    buffer_atomic_add v16, v2, s[40:43], 0 offen offset:16 sc0 sc1
    s_waitcnt vmcnt(0)
    v_add_u32 v16, 1, v16
    ds_write_b32 v17, v16 offset:12
    s_mov_b64 exec, -1
L_waitrole:
    s_mov_b32 s54, 1600000
L_pollr:
    ds_read_b32 v16, v17 offset:12
    s_waitcnt lgkmcnt(0)
    v_readfirstlane_b32 s63, v16
    s_cmp_lg_u32 s63, 0
    s_cbranch_scc1 L_gotr
    s_sleep 2
    s_sub_u32 s54, s54, 1
    s_cmp_lg_u32 s54, 0
    s_cbranch_scc1 L_pollr
L_gotr:
    s_sub_u32 s63, s63, 1
    s_cmp_lt_u32 s63, 28
    s_cbranch_scc0 L_norole
    s_mul_i32 s9, s3, 896
    s_add_u32 s40, s16, s9
    s_addc_u32 s41, s17, 0
    s_mov_b32 s42, 896
    s_mov_b32 s43, 0x20000
    v_bfe_u32 v16, v1, 2, 2
    v_lshlrev_b32 v16, 1, v16
    v_bfe_u32 v17, v1, 4, 1
    v_add_u32 v16, v16, v17
    v_lshrrev_b32 v17, 5, v1
    v_and_b32 v18, 3, v1
    v_lshl_add_u32 v17, v17, 2, v18
    v_lshlrev_b32 v18, 6, v17
    v_lshl_add_u32 v18, v16, 1, v18
    buffer_load_ushort v8, v18, s[40:43], 0 offen offset:0
    buffer_load_ushort v9, v18, s[40:43], 0 offen offset:16
    buffer_load_ushort v10, v18, s[40:43], 0 offen offset:32
    buffer_load_ushort v11, v18, s[40:43], 0 offen offset:48
    buffer_load_ushort v12, v18, s[40:43], 0 offen offset:512
    buffer_load_ushort v13, v18, s[40:43], 0 offen offset:528
    buffer_load_ushort v14, v18, s[40:43], 0 offen offset:544
    buffer_load_ushort v15, v18, s[40:43], 0 offen offset:560
    v_lshlrev_b32 v78, 6, v17
    v_lshl_add_u32 v78, v16, 3, v78
    s_mul_i32 s9, s3, 1040
    v_add_u32 v78, s9, v78
    s_lshl_b32 s9, s63, 7
    s_mul_i32 s10, s3, 28672
    s_add_u32 s9, s9, s10
    s_sub_u32 s10, 1605632, s9
    s_add_u32 s40, s28, s9
    s_addc_u32 s41, s29, 0
    s_mov_b32 s42, s10
    s_mov_b32 s43, 0x20000
    s_add_u32 s44, s30, s9
    s_addc_u32 s45, s31, 0
    s_mov_b32 s46, s10
    s_mov_b32 s47, 0x20000
    v_mul_u32_u24 v24, 3584, v3
    v_lshl_add_u32 v24, v4, 4, v24
    s_mov_b32 s48, 0
    buffer_load_dwordx4 v[80:83], v24, s[40:43], s48 offen
    s_mov_b32 s48, 114688
    buffer_load_dwordx4 v[84:87], v24, s[40:43], s48 offen
    s_mov_b32 s48, 229376
    buffer_load_dwordx4 v[88:91], v24, s[40:43], s48 offen
    s_mov_b32 s48, 344064
    buffer_load_dwordx4 v[92:95], v24, s[40:43], s48 offen
    s_mov_b32 s48, 458752
    buffer_load_dwordx4 v[96:99], v24, s[40:43], s48 offen
    s_mov_b32 s48, 573440
    buffer_load_dwordx4 v[100:103], v24, s[40:43], s48 offen
    s_mov_b32 s48, 688128
    buffer_load_dwordx4 v[104:107], v24, s[40:43], s48 offen
    s_mov_b32 s48, 802816
    buffer_load_dwordx4 v[108:111], v24, s[40:43], s48 offen
    s_mov_b32 s48, 917504
    buffer_load_dwordx4 v[112:115], v24, s[40:43], s48 offen
    s_mov_b32 s48, 1032192
    buffer_load_dwordx4 v[116:119], v24, s[40:43], s48 offen
    s_mov_b32 s48, 1146880
    buffer_load_dwordx4 v[120:123], v24, s[40:43], s48 offen
    s_mov_b32 s48, 1261568
    buffer_load_dwordx4 v[124:127], v24, s[40:43], s48 offen
    s_mov_b32 s48, 1376256
    buffer_load_dwordx4 v[128:131], v24, s[40:43], s48 offen
    s_mov_b32 s48, 1490944
    buffer_load_dwordx4 v[132:135], v24, s[40:43], s48 offen
    s_mov_b32 s48, 0
    buffer_load_dwordx4 v[200:203], v24, s[44:47], s48 offen
    s_mov_b32 s48, 114688
    buffer_load_dwordx4 v[204:207], v24, s[44:47], s48 offen
    s_mov_b32 s48, 229376
    buffer_load_dwordx4 v[208:211], v24, s[44:47], s48 offen
    s_mov_b32 s48, 344064
    buffer_load_dwordx4 v[212:215], v24, s[44:47], s48 offen
    s_mov_b32 s48, 458752
    buffer_load_dwordx4 v[216:219], v24, s[44:47], s48 offen
    s_mov_b32 s48, 573440
    buffer_load_dwordx4 v[220:223], v24, s[44:47], s48 offen
    s_mov_b32 s48, 688128
    buffer_load_dwordx4 v[224:227], v24, s[44:47], s48 offen
    s_mov_b32 s48, 802816
    buffer_load_dwordx4 v[228:231], v24, s[44:47], s48 offen
    s_mov_b32 s48, 917504
    buffer_load_dwordx4 v[232:235], v24, s[44:47], s48 offen
    s_mov_b32 s48, 1032192
    buffer_load_dwordx4 v[236:239], v24, s[44:47], s48 offen
    s_mov_b32 s48, 1146880
    buffer_load_dwordx4 v[240:243], v24, s[44:47], s48 offen
    s_mov_b32 s48, 1261568
    buffer_load_dwordx4 v[244:247], v24, s[44:47], s48 offen
    s_mov_b32 s48, 1376256
    buffer_load_dwordx4 v[248:251], v24, s[44:47], s48 offen
    s_mov_b32 s48, 1490944
    buffer_load_dwordx4 v[252:255], v24, s[44:47], s48 offen
    v_bfe_u32 v16, v1, 4, 1
    v_lshl_add_u32 v16, v16, 2, v4
    v_add_u32 v16, s3, v16
    s_lshl_b32 s9, s3, 11
    s_add_u32 s9, s9, 40960
    v_lshlrev_b32 v17, 8, v3
    v_add_u32 v17, s9, v17
    v_lshl_add_u32 v18, v16, 4, v17
    v_add_u32 v19, 0x10000, v18
    v_xor_b32 v20, 0x80, v18
    v_xor_b32 v21, 0x80, v19
    s_mul_i32 s9, s63, 57344
    s_mul_i32 s10, s3, 14336
    s_add_u32 s9, s9, s10
    s_add_u32 s40, s32, s9
    s_addc_u32 s41, s33, 0
    s_mov_b32 s42, 14336
    s_mov_b32 s43, 0x20000
    v_lshlrev_b32 v24, 4, v1
    s_waitcnt vmcnt(27)
    ds_write_b128 v18, v[80:83] offset:0
    s_waitcnt vmcnt(26)
    ds_write_b128 v18, v[84:87] offset:8192
    s_waitcnt vmcnt(25)
    ds_write_b128 v18, v[88:91] offset:16384
    s_waitcnt vmcnt(24)
    ds_write_b128 v18, v[92:95] offset:24576
    s_waitcnt vmcnt(23)
    ds_write_b128 v18, v[96:99] offset:32768
    s_waitcnt vmcnt(22)
    ds_write_b128 v18, v[100:103] offset:40960
    s_waitcnt vmcnt(21)
    ds_write_b128 v18, v[104:107] offset:49152
    s_waitcnt vmcnt(20)
    ds_write_b128 v18, v[108:111] offset:57344
    s_waitcnt vmcnt(19)
    ds_write_b128 v19, v[112:115] offset:0
    s_waitcnt vmcnt(18)
    ds_write_b128 v19, v[116:119] offset:8192
    s_waitcnt vmcnt(17)
    ds_write_b128 v19, v[120:123] offset:16384
    s_waitcnt vmcnt(16)
    ds_write_b128 v19, v[124:127] offset:24576
    s_waitcnt vmcnt(15)
    ds_write_b128 v19, v[128:131] offset:32768
    s_waitcnt vmcnt(14)
    ds_write_b128 v19, v[132:135] offset:40960
    s_waitcnt vmcnt(13)
    ds_write_b128 v20, v[200:203] offset:0
    s_waitcnt vmcnt(12)
    ds_write_b128 v20, v[204:207] offset:8192
    s_waitcnt vmcnt(11)
    ds_write_b128 v20, v[208:211] offset:16384
    s_waitcnt vmcnt(10)
    ds_write_b128 v20, v[212:215] offset:24576
    s_waitcnt vmcnt(9)
    ds_write_b128 v20, v[216:219] offset:32768
    s_waitcnt vmcnt(8)
    ds_write_b128 v20, v[220:223] offset:40960
    s_waitcnt vmcnt(7)
    ds_write_b128 v20, v[224:227] offset:49152
    s_waitcnt vmcnt(6)
    ds_write_b128 v20, v[228:231] offset:57344
    s_waitcnt vmcnt(5)
    ds_write_b128 v21, v[232:235] offset:0
    s_waitcnt vmcnt(4)
    ds_write_b128 v21, v[236:239] offset:8192
    s_waitcnt vmcnt(3)
    ds_write_b128 v21, v[240:243] offset:16384
    s_waitcnt vmcnt(2)
    ds_write_b128 v21, v[244:247] offset:24576
    s_waitcnt vmcnt(1)
    ds_write_b128 v21, v[248:251] offset:32768
    s_waitcnt vmcnt(0)
    ds_write_b128 v21, v[252:255] offset:40960
    s_waitcnt lgkmcnt(0)
    v_mov_b32 v16, 16896
    v_mov_b32 v17, 1
    s_mov_b64 exec, 1
    ds_add_u32 v16, v17 offset:48
    s_mov_b64 exec, -1
    s_mov_b32 exec_hi, 0x00ffffff
    s_mov_b32 s48, 0
    buffer_load_dwordx4 v[200:203], v24, s[40:43], s48 offen offset:0
    s_mov_b32 s48, 0
    buffer_load_dwordx4 v[204:207], v24, s[40:43], s48 offen offset:896
    s_mov_b32 s48, 0
    buffer_load_dwordx4 v[208:211], v24, s[40:43], s48 offen offset:1792
    s_mov_b32 s48, 0
    buffer_load_dwordx4 v[212:215], v24, s[40:43], s48 offen offset:2688
    s_mov_b32 s48, 3584
    buffer_load_dwordx4 v[216:219], v24, s[40:43], s48 offen offset:0
    s_mov_b32 s48, 3584
    buffer_load_dwordx4 v[220:223], v24, s[40:43], s48 offen offset:896
    s_mov_b32 s48, 3584
    buffer_load_dwordx4 v[224:227], v24, s[40:43], s48 offen offset:1792
    s_mov_b32 s48, 3584
    buffer_load_dwordx4 v[228:231], v24, s[40:43], s48 offen offset:2688
    s_mov_b32 s48, 7168
    buffer_load_dwordx4 v[232:235], v24, s[40:43], s48 offen offset:0
    s_mov_b32 s48, 7168
    buffer_load_dwordx4 v[236:239], v24, s[40:43], s48 offen offset:896
    s_mov_b32 s48, 7168
    buffer_load_dwordx4 v[240:243], v24, s[40:43], s48 offen offset:1792
    s_mov_b32 s48, 7168
    buffer_load_dwordx4 v[244:247], v24, s[40:43], s48 offen offset:2688
    s_mov_b32 s48, 10752
    buffer_load_dwordx4 v[248:251], v24, s[40:43], s48 offen offset:0
    s_mov_b32 s48, 10752
    buffer_load_dwordx4 v[252:255], v24, s[40:43], s48 offen offset:896
    s_mov_b32 s48, 10752
    buffer_load_dwordx4 v[32:35], v24, s[40:43], s48 offen offset:1792
    s_mov_b32 s48, 10752
    buffer_load_dwordx4 v[36:39], v24, s[40:43], s48 offen offset:2688
    s_mov_b64 exec, -1
    s_mov_b32 s54, 1600000
L_pollf:
    ds_read_b32 v17, v16 offset:48
    s_waitcnt lgkmcnt(0)
    v_readfirstlane_b32 s10, v17
    s_cmp_eq_u32 s10, 4
    s_cbranch_scc1 L_gotf
    s_sleep 2
    s_sub_u32 s54, s54, 1
    s_cmp_lg_u32 s54, 0
    s_cbranch_scc1 L_pollf
L_gotf:
    v_lshrrev_b32 v30, 4, v1
    v_bfe_u32 v31, v1, 2, 2
    v_lshlrev_b32 v28, 9, v30
    v_lshl_add_u32 v28, v31, 11, v28
    v_and_b32 v30, 1, v30
    v_lshl_add_u32 v31, v30, 2, v31
    v_and_b32 v30, 2, v1
    v_lshl_add_u32 v31, v30, 2, v31
    v_add_u32 v31, s62, v31
    v_and_b32 v31, 15, v31
    v_lshl_add_u32 v28, v31, 4, v28
    v_and_b32 v30, 1, v1
    v_lshl_add_u32 v28, v30, 3, v28
    v_add_u32 v28, 40960, v28
    v_add_u32 v29, 0x10000, v28
    ds_read_b64_tr_b16 v[80:81], v28 offset:0
    ds_read_b64_tr_b16 v[82:83], v28 offset:256
    ds_read_b64_tr_b16 v[84:85], v28 offset:8192
    ds_read_b64_tr_b16 v[86:87], v28 offset:8448
    ds_read_b64_tr_b16 v[88:89], v28 offset:16384
    ds_read_b64_tr_b16 v[90:91], v28 offset:16640
    ds_read_b64_tr_b16 v[92:93], v28 offset:24576
    ds_read_b64_tr_b16 v[94:95], v28 offset:24832
    ds_read_b64_tr_b16 v[96:97], v28 offset:32768
    ds_read_b64_tr_b16 v[98:99], v28 offset:33024
    ds_read_b64_tr_b16 v[100:101], v28 offset:40960
    ds_read_b64_tr_b16 v[102:103], v28 offset:41216
    ds_read_b64_tr_b16 v[104:105], v28 offset:49152
    ds_read_b64_tr_b16 v[106:107], v28 offset:49408
    ds_read_b64_tr_b16 v[108:109], v28 offset:57344
    ds_read_b64_tr_b16 v[110:111], v28 offset:57600
    ds_read_b64_tr_b16 v[112:113], v29 offset:0
    ds_read_b64_tr_b16 v[114:115], v29 offset:256
    ds_read_b64_tr_b16 v[116:117], v29 offset:8192
    ds_read_b64_tr_b16 v[118:119], v29 offset:8448
    ds_read_b64_tr_b16 v[120:121], v29 offset:16384
    ds_read_b64_tr_b16 v[122:123], v29 offset:16640
    ds_read_b64_tr_b16 v[124:125], v29 offset:24576
    ds_read_b64_tr_b16 v[126:127], v29 offset:24832
    ds_read_b64_tr_b16 v[128:129], v29 offset:32768
    ds_read_b64_tr_b16 v[130:131], v29 offset:33024
    ds_read_b64_tr_b16 v[132:133], v29 offset:40960
    ds_read_b64_tr_b16 v[134:135], v29 offset:41216
    v_lshlrev_b32 v8, 16, v8
    v_lshlrev_b32 v9, 16, v9
    v_lshlrev_b32 v10, 16, v10
    v_lshlrev_b32 v11, 16, v11
    v_lshlrev_b32 v12, 16, v12
    v_lshlrev_b32 v13, 16, v13
    v_lshlrev_b32 v14, 16, v14
    v_lshlrev_b32 v15, 16, v15
    s_mul_i32 s9, s3, 14848
    s_add_u32 s9, s9, 40960
    v_lshlrev_b32 v79, 4, v1
    v_add_u32 v79, s9, v79
L_norole:
    v_and_b32 v17, 15, v1
    v_lshrrev_b32 v18, 4, v1
    v_lshlrev_b32 v5, 4, v17
    v_lshl_add_u32 v5, v18, 2, v5
    v_lshlrev_b32 v6, 2, v1
    v_lshlrev_b32 v7, 7, v1
    v_mov_b32 v18, 1
    s_lshl_b32 s50, s5, 12
    s_add_u32 s50, s50, 1048576
    s_lshl_b32 s9, s3, 9
    s_add_u32 s51, s50, s9
    s_waitcnt vmcnt(0) lgkmcnt(0)
    s_barrier
    ds_read2st64_b32 v[20:21], v5 offset0:80 offset1:81
    ds_read2st64_b32 v[22:23], v5 offset0:82 offset1:83
    ds_read2st64_b32 v[24:25], v5 offset0:84 offset1:85
    ds_read2st64_b32 v[26:27], v5 offset0:86 offset1:87
    s_waitcnt lgkmcnt(0)
    v_add_f32 v20, v20, v24
    v_add_f32 v21, v21, v25
    v_add_f32 v22, v22, v26
    v_add_f32 v23, v23, v27
    v_add_f32 v20, v20, v21
    v_add_f32 v22, v22, v23
    v_add_f32 v20, v20, v22
    v_cvt_pk_bf16_f32 v16, v20, v20
    v_mov_b32 v72, 0
    v_mov_b32 v73, 0
    v_mov_b32 v74, 0
    v_mov_b32 v75, 0
    v_and_b32_dpp v64, v16, v60 row_newbcast:0 row_mask:0xf bank_mask:0xf
    v_and_b32_dpp v65, v16, v61 row_newbcast:0 row_mask:0xf bank_mask:0xf
    v_and_b32_dpp v66, v16, v62 row_newbcast:0 row_mask:0xf bank_mask:0xf
    v_and_b32_dpp v67, v16, v63 row_newbcast:0 row_mask:0xf bank_mask:0xf
    v_and_b32_dpp v68, v16, v60 row_newbcast:1 row_mask:0xf bank_mask:0xf
    v_and_b32_dpp v69, v16, v61 row_newbcast:1 row_mask:0xf bank_mask:0xf
    v_and_b32_dpp v70, v16, v62 row_newbcast:1 row_mask:0xf bank_mask:0xf
    v_and_b32_dpp v71, v16, v63 row_newbcast:1 row_mask:0xf bank_mask:0xf
    v_mfma_f32_16x16x32_bf16 v[72:75], v[64:67], v[136:139], v[72:75]
    v_and_b32_dpp v64, v16, v60 row_newbcast:2 row_mask:0xf bank_mask:0xf
    v_and_b32_dpp v65, v16, v61 row_newbcast:2 row_mask:0xf bank_mask:0xf
    v_and_b32_dpp v66, v16, v62 row_newbcast:2 row_mask:0xf bank_mask:0xf
    v_and_b32_dpp v67, v16, v63 row_newbcast:2 row_mask:0xf bank_mask:0xf
    v_mfma_f32_16x16x32_bf16 v[72:75], v[68:71], v[140:143], v[72:75]
    v_and_b32_dpp v68, v16, v60 row_newbcast:3 row_mask:0xf bank_mask:0xf
    v_and_b32_dpp v69, v16, v61 row_newbcast:3 row_mask:0xf bank_mask:0xf
    v_and_b32_dpp v70, v16, v62 row_newbcast:3 row_mask:0xf bank_mask:0xf
    v_and_b32_dpp v71, v16, v63 row_newbcast:3 row_mask:0xf bank_mask:0xf
    v_mfma_f32_16x16x32_bf16 v[72:75], v[64:67], v[144:147], v[72:75]
    v_and_b32_dpp v64, v16, v60 row_newbcast:4 row_mask:0xf bank_mask:0xf
    v_and_b32_dpp v65, v16, v61 row_newbcast:4 row_mask:0xf bank_mask:0xf
    v_and_b32_dpp v66, v16, v62 row_newbcast:4 row_mask:0xf bank_mask:0xf
    v_and_b32_dpp v67, v16, v63 row_newbcast:4 row_mask:0xf bank_mask:0xf
    v_mfma_f32_16x16x32_bf16 v[72:75], v[68:71], v[148:151], v[72:75]
    v_and_b32_dpp v68, v16, v60 row_newbcast:5 row_mask:0xf bank_mask:0xf
    v_and_b32_dpp v69, v16, v61 row_newbcast:5 row_mask:0xf bank_mask:0xf
    v_and_b32_dpp v70, v16, v62 row_newbcast:5 row_mask:0xf bank_mask:0xf
    v_and_b32_dpp v71, v16, v63 row_newbcast:5 row_mask:0xf bank_mask:0xf
    v_mfma_f32_16x16x32_bf16 v[72:75], v[64:67], v[152:155], v[72:75]
    v_and_b32_dpp v64, v16, v60 row_newbcast:6 row_mask:0xf bank_mask:0xf
    v_and_b32_dpp v65, v16, v61 row_newbcast:6 row_mask:0xf bank_mask:0xf
    v_and_b32_dpp v66, v16, v62 row_newbcast:6 row_mask:0xf bank_mask:0xf
    v_and_b32_dpp v67, v16, v63 row_newbcast:6 row_mask:0xf bank_mask:0xf
    v_mfma_f32_16x16x32_bf16 v[72:75], v[68:71], v[156:159], v[72:75]
    v_and_b32_dpp v68, v16, v60 row_newbcast:7 row_mask:0xf bank_mask:0xf
    v_and_b32_dpp v69, v16, v61 row_newbcast:7 row_mask:0xf bank_mask:0xf
    v_and_b32_dpp v70, v16, v62 row_newbcast:7 row_mask:0xf bank_mask:0xf
    v_and_b32_dpp v71, v16, v63 row_newbcast:7 row_mask:0xf bank_mask:0xf
    v_mfma_f32_16x16x32_bf16 v[72:75], v[64:67], v[160:163], v[72:75]
    v_and_b32_dpp v64, v16, v60 row_newbcast:8 row_mask:0xf bank_mask:0xf
    v_and_b32_dpp v65, v16, v61 row_newbcast:8 row_mask:0xf bank_mask:0xf
    v_and_b32_dpp v66, v16, v62 row_newbcast:8 row_mask:0xf bank_mask:0xf
    v_and_b32_dpp v67, v16, v63 row_newbcast:8 row_mask:0xf bank_mask:0xf
    v_mfma_f32_16x16x32_bf16 v[72:75], v[68:71], v[164:167], v[72:75]
    v_and_b32_dpp v68, v16, v60 row_newbcast:9 row_mask:0xf bank_mask:0xf
    v_and_b32_dpp v69, v16, v61 row_newbcast:9 row_mask:0xf bank_mask:0xf
    v_and_b32_dpp v70, v16, v62 row_newbcast:9 row_mask:0xf bank_mask:0xf
    v_and_b32_dpp v71, v16, v63 row_newbcast:9 row_mask:0xf bank_mask:0xf
    v_mfma_f32_16x16x32_bf16 v[72:75], v[64:67], v[168:171], v[72:75]
    v_and_b32_dpp v64, v16, v60 row_newbcast:10 row_mask:0xf bank_mask:0xf
    v_and_b32_dpp v65, v16, v61 row_newbcast:10 row_mask:0xf bank_mask:0xf
    v_and_b32_dpp v66, v16, v62 row_newbcast:10 row_mask:0xf bank_mask:0xf
    v_and_b32_dpp v67, v16, v63 row_newbcast:10 row_mask:0xf bank_mask:0xf
    v_mfma_f32_16x16x32_bf16 v[72:75], v[68:71], v[172:175], v[72:75]
    v_and_b32_dpp v68, v16, v60 row_newbcast:11 row_mask:0xf bank_mask:0xf
    v_and_b32_dpp v69, v16, v61 row_newbcast:11 row_mask:0xf bank_mask:0xf
    v_and_b32_dpp v70, v16, v62 row_newbcast:11 row_mask:0xf bank_mask:0xf
    v_and_b32_dpp v71, v16, v63 row_newbcast:11 row_mask:0xf bank_mask:0xf
    v_mfma_f32_16x16x32_bf16 v[72:75], v[64:67], v[176:179], v[72:75]
    v_and_b32_dpp v64, v16, v60 row_newbcast:12 row_mask:0xf bank_mask:0xf
    v_and_b32_dpp v65, v16, v61 row_newbcast:12 row_mask:0xf bank_mask:0xf
    v_and_b32_dpp v66, v16, v62 row_newbcast:12 row_mask:0xf bank_mask:0xf
    v_and_b32_dpp v67, v16, v63 row_newbcast:12 row_mask:0xf bank_mask:0xf
    v_mfma_f32_16x16x32_bf16 v[72:75], v[68:71], v[180:183], v[72:75]
    v_and_b32_dpp v68, v16, v60 row_newbcast:13 row_mask:0xf bank_mask:0xf
    v_and_b32_dpp v69, v16, v61 row_newbcast:13 row_mask:0xf bank_mask:0xf
    v_and_b32_dpp v70, v16, v62 row_newbcast:13 row_mask:0xf bank_mask:0xf
    v_and_b32_dpp v71, v16, v63 row_newbcast:13 row_mask:0xf bank_mask:0xf
    v_mfma_f32_16x16x32_bf16 v[72:75], v[64:67], v[184:187], v[72:75]
    v_and_b32_dpp v64, v16, v60 row_newbcast:14 row_mask:0xf bank_mask:0xf
    v_and_b32_dpp v65, v16, v61 row_newbcast:14 row_mask:0xf bank_mask:0xf
    v_and_b32_dpp v66, v16, v62 row_newbcast:14 row_mask:0xf bank_mask:0xf
    v_and_b32_dpp v67, v16, v63 row_newbcast:14 row_mask:0xf bank_mask:0xf
    v_mfma_f32_16x16x32_bf16 v[72:75], v[68:71], v[188:191], v[72:75]
    v_and_b32_dpp v68, v16, v60 row_newbcast:15 row_mask:0xf bank_mask:0xf
    v_and_b32_dpp v69, v16, v61 row_newbcast:15 row_mask:0xf bank_mask:0xf
    v_and_b32_dpp v70, v16, v62 row_newbcast:15 row_mask:0xf bank_mask:0xf
    v_and_b32_dpp v71, v16, v63 row_newbcast:15 row_mask:0xf bank_mask:0xf
    v_mfma_f32_16x16x32_bf16 v[72:75], v[64:67], v[192:195], v[72:75]
    s_nop 0
    v_mfma_f32_16x16x32_bf16 v[72:75], v[68:71], v[196:199], v[72:75]
    s_mov_b64 exec, s[60:61]
    s_nop 6
    buffer_atomic_add_f32 v72, v6, s[12:15], s51 offen sc1
    buffer_atomic_add_f32 v73, v6, s[12:15], s51 offen offset:256 sc1
    s_cmp_lt_u32 s63, 28
    s_cbranch_scc0 L_cnt
    s_barrier
    s_mov_b32 exec_lo, -1
    s_mov_b32 exec_hi, 0x00ffffff
    ds_write_b128 v79, v[200:203] offset:0
    ds_write_b128 v79, v[204:207] offset:928
    ds_write_b128 v79, v[208:211] offset:1856
    ds_write_b128 v79, v[212:215] offset:2784
    ds_write_b128 v79, v[216:219] offset:3712
    ds_write_b128 v79, v[220:223] offset:4640
    ds_write_b128 v79, v[224:227] offset:5568
    ds_write_b128 v79, v[228:231] offset:6496
    ds_write_b128 v79, v[232:235] offset:7424
    ds_write_b128 v79, v[236:239] offset:8352
    ds_write_b128 v79, v[240:243] offset:9280
    ds_write_b128 v79, v[244:247] offset:10208
    ds_write_b128 v79, v[248:251] offset:11136
    ds_write_b128 v79, v[252:255] offset:12064
    ds_write_b128 v79, v[32:35] offset:12992
    ds_write_b128 v79, v[36:39] offset:13920
L_cnt:
    s_mov_b64 exec, 15
    s_waitcnt vmcnt(0)
    buffer_atomic_add v18, v7, s[12:15], s50 offen offset:2048 sc1
    s_mov_b64 exec, -1
    s_cbranch_scc0 L_done
L_ffn:
    v_lshrrev_b32 v18, 4, v1
    v_bfe_u32 v19, v1, 2, 2
    v_and_b32 v20, 3, v1
    v_mul_u32_u24 v184, 1040, v20
    v_lshl_add_u32 v184, v19, 6, v184
    v_lshl_add_u32 v184, v18, 4, v184
    v_mul_u32_u24 v185, 144, v20
    v_lshl_add_u32 v186, v18, 4, v185
    v_and_b32 v21, 1, v18
    v_lshl_add_u32 v185, v21, 3, v185
    v_lshrrev_b32 v21, 5, v1
    v_lshl_add_u32 v185, v21, 2, v185
    s_lshl_b32 s9, s62, 4
    v_add_u32 v185, s9, v185
    v_lshlrev_b32 v187, 12, v3
    v_lshl_add_u32 v187, v4, 4, v187
    v_lshlrev_b32 v188, 4, v1
    s_lshl_b32 s68, s62, 15
    s_lshl_b32 s9, s63, 7
    s_add_u32 s68, s68, s9
    s_add_u32 s68, s68, 2097152
    v_lshl_add_u32 v191, v18, 3, v19
    v_mul_u32_u24 v191, 928, v191
    v_lshl_add_u32 v191, v20, 3, v191
    s_min_u32 s9, s62, 6
    s_lshl_b32 s9, s9, 7
    s_add_u32 s9, s9, 40960
    v_add_u32 v191, s9, v191
    s_lshl_b32 s9, s63, 1
    s_and_b32 s10, s62, 1
    s_add_u32 s9, s9, s10
    s_lshl_b32 s69, s9, 12
    s_add_u32 s69, s69, 2097152
    s_lshr_b32 s64, s9, 3
    s_lshl_b32 s64, s64, 6
    s_lshl_b32 s10, s10, 5
    s_add_u32 s64, s64, s10
    s_bfe_u32 s10, s9, 0x20001
    s_lshl_b32 s10, s10, 2
    s_add_u32 s64, s64, s10
    v_and_b32 v21, 4, v1
    v_lshlrev_b32 v21, 2, v21
    v_add_u32 v21, s64, v21
    v_mul_u32_u24 v190, 896, v20
    v_lshl_add_u32 v190, v21, 1, v190
    v_lshrrev_b32 v189, 7, v21
    v_lshlrev_b32 v189, 9, v189
    v_lshl_add_u32 v189, v20, 11, v189
    v_bfe_u32 v22, v21, 3, 4
    v_lshl_add_u32 v189, v22, 2, v189
    v_and_b32 v22, 4, v21
    v_lshl_add_u32 v189, v22, 5, v189
    s_mov_b32 s44, s34
    s_mov_b32 s45, s35
    s_mov_b32 s46, 3584
    s_mov_b32 s47, 0x20000
    s_mov_b32 s72, 0xf000f0
    s_mov_b32 s73, 0xf000f0
    s_mov_b32 s74, 0xf000f00
    s_mov_b32 s75, 0xf000f00
    s_mov_b32 s76, 0xf000f000
    s_mov_b32 s77, 0xf000f000
    s_waitcnt lgkmcnt(0)
    s_barrier
    ds_read_b64_tr_b16 v[136:137], v191 offset:0
    ds_read_b64_tr_b16 v[138:139], v191 offset:3712
    ds_read_b64_tr_b16 v[140:141], v191 offset:29696
    ds_read_b64_tr_b16 v[142:143], v191 offset:33408
    ds_read_b64_tr_b16 v[144:145], v191 offset:32
    ds_read_b64_tr_b16 v[146:147], v191 offset:3744
    ds_read_b64_tr_b16 v[148:149], v191 offset:29728
    ds_read_b64_tr_b16 v[150:151], v191 offset:33440
    ds_read_b64_tr_b16 v[152:153], v191 offset:64
    ds_read_b64_tr_b16 v[154:155], v191 offset:3776
    ds_read_b64_tr_b16 v[156:157], v191 offset:29760
    ds_read_b64_tr_b16 v[158:159], v191 offset:33472
    ds_read_b64_tr_b16 v[160:161], v191 offset:96
    ds_read_b64_tr_b16 v[162:163], v191 offset:3808
    ds_read_b64_tr_b16 v[164:165], v191 offset:29792
    ds_read_b64_tr_b16 v[166:167], v191 offset:33504
    v_mov_b32 v168, 0
    v_mov_b32 v169, 0
    v_mov_b32 v170, 0
    v_mov_b32 v171, 0
    v_mov_b32 v172, 0
    v_mov_b32 v173, 0
    v_mov_b32 v174, 0
    v_mov_b32 v175, 0
    v_mov_b32 v176, 0
    v_mov_b32 v177, 0
    v_mov_b32 v178, 0
    v_mov_b32 v179, 0
    v_mov_b32 v180, 0
    v_mov_b32 v181, 0
    v_mov_b32 v182, 0
    v_mov_b32 v183, 0
    s_cmp_lt_u32 s62, 4
    s_cbranch_scc1 L_f1wait
    s_mov_b32 s52, -1
    s_mov_b32 s53, 0x33333333
    s_lshl_b32 s50, s3, 12
    s_add_u32 s50, s50, 1048576
    s_and_b32 s9, s63, 3
    s_lshl_b32 s9, s9, 7
    s_add_u32 s9, s9, s50
    s_mov_b32 s54, 200000
    s_lshl_b32 s10, s3, 11
    v_add_u32 v79, s10, v188
L_polly:
    buffer_load_dword v16, v2, s[12:15], s9 offen offset:2048 sc1
    s_waitcnt vmcnt(0)
    v_readfirstlane_b32 s10, v16
    s_cmp_eq_u32 s10, 256
    s_cbranch_scc1 L_goty
    s_sleep 1
    s_sub_u32 s54, s54, 1
    s_cmp_lg_u32 s54, 0
    s_cbranch_scc1 L_polly
L_goty:
    buffer_load_dwordx4 v[32:35], v188, s[12:15], s50 offen sc1
    buffer_load_dwordx4 v[36:39], v188, s[12:15], s50 offen offset:1024 sc1
    s_waitcnt vmcnt(0)
    v_cvt_pk_bf16_f32 v32, v32, v32
    v_and_b32 v32, 0xffff0000, v32
    v_cvt_pk_bf16_f32 v33, v33, v33
    v_and_b32 v33, 0xffff0000, v33
    v_cvt_pk_bf16_f32 v34, v34, v34
    v_and_b32 v34, 0xffff0000, v34
    v_cvt_pk_bf16_f32 v35, v35, v35
    v_and_b32 v35, 0xffff0000, v35
    v_cvt_pk_bf16_f32 v36, v36, v36
    v_and_b32 v36, 0xffff0000, v36
    v_cvt_pk_bf16_f32 v37, v37, v37
    v_and_b32 v37, 0xffff0000, v37
    v_cvt_pk_bf16_f32 v38, v38, v38
    v_and_b32 v38, 0xffff0000, v38
    v_cvt_pk_bf16_f32 v39, v39, v39
    v_and_b32 v39, 0xffff0000, v39
    v_add_f32 v32, v32, v8
    v_add_f32 v33, v33, v9
    v_add_f32 v34, v34, v10
    v_add_f32 v35, v35, v11
    v_add_f32 v36, v36, v12
    v_add_f32 v37, v37, v13
    v_add_f32 v38, v38, v14
    v_add_f32 v39, v39, v15
    v_cvt_pk_bf16_f32 v32, v32, v32
    v_and_b32 v32, 0xffff0000, v32
    v_cvt_pk_bf16_f32 v33, v33, v33
    v_and_b32 v33, 0xffff0000, v33
    v_cvt_pk_bf16_f32 v34, v34, v34
    v_and_b32 v34, 0xffff0000, v34
    v_cvt_pk_bf16_f32 v35, v35, v35
    v_and_b32 v35, 0xffff0000, v35
    v_cvt_pk_bf16_f32 v36, v36, v36
    v_and_b32 v36, 0xffff0000, v36
    v_cvt_pk_bf16_f32 v37, v37, v37
    v_and_b32 v37, 0xffff0000, v37
    v_cvt_pk_bf16_f32 v38, v38, v38
    v_and_b32 v38, 0xffff0000, v38
    v_cvt_pk_bf16_f32 v39, v39, v39
    v_and_b32 v39, 0xffff0000, v39
    ds_write_b128 v79, v[32:35] offset:22528
    ds_write_b128 v79, v[36:39] offset:23552
    v_add_f32 v16, v32, v33
    v_add_f32 v17, v34, v35
    v_add_f32 v18, v36, v37
    v_add_f32 v19, v38, v39
    v_add_f32 v16, v16, v17
    v_add_f32 v18, v18, v19
    v_add_f32 v16, v16, v18
    s_nop 1
    v_add_f32_dpp v16, v16, v16 quad_perm:[1,0,3,2] row_mask:0xf bank_mask:0xf
    s_nop 1
    v_add_f32_dpp v16, v16, v16 quad_perm:[2,3,0,1] row_mask:0xf bank_mask:0xf
    s_nop 1
    v_add_f32_dpp v16, v16, v16 row_half_mirror row_mask:0xf bank_mask:0xf
    s_nop 1
    v_add_f32_dpp v16, v16, v16 row_mirror row_mask:0xf bank_mask:0xf
    s_nop 0
    v_readlane_b32 s56, v16, 0
    v_readlane_b32 s57, v16, 16
    v_readlane_b32 s58, v16, 32
    v_readlane_b32 s59, v16, 48
    v_mov_b32 v16, s56
    v_add_f32 v16, s57, v16
    v_add_f32 v16, s58, v16
    v_add_f32 v16, s59, v16
    v_mul_f32 v16, 2.2321428571e-03, v16
    v_sub_f32 v20, v32, v16
    v_sub_f32 v21, v33, v16
    v_sub_f32 v22, v34, v16
    v_sub_f32 v23, v35, v16
    v_sub_f32 v24, v36, v16
    v_sub_f32 v25, v37, v16
    v_sub_f32 v26, v38, v16
    v_sub_f32 v27, v39, v16
    v_cndmask_b32 v24, 0, v24, s[52:53]
    v_cndmask_b32 v25, 0, v25, s[52:53]
    v_cndmask_b32 v26, 0, v26, s[52:53]
    v_cndmask_b32 v27, 0, v27, s[52:53]
    v_mul_f32 v17, v20, v20
    v_mul_f32 v18, v21, v21
    v_fmac_f32 v17, v22, v22
    v_fmac_f32 v18, v23, v23
    v_fmac_f32 v17, v24, v24
    v_fmac_f32 v18, v25, v25
    v_fmac_f32 v17, v26, v26
    v_fmac_f32 v18, v27, v27
    v_add_f32 v17, v17, v18
    v_cvt_pk_bf16_f32 v16, v16, v16
    v_and_b32 v16, 0xffff0000, v16
    v_add_f32_dpp v17, v17, v17 quad_perm:[1,0,3,2] row_mask:0xf bank_mask:0xf
    s_nop 1
    v_add_f32_dpp v17, v17, v17 quad_perm:[2,3,0,1] row_mask:0xf bank_mask:0xf
    s_nop 1
    v_add_f32_dpp v17, v17, v17 row_half_mirror row_mask:0xf bank_mask:0xf
    s_nop 1
    v_add_f32_dpp v17, v17, v17 row_mirror row_mask:0xf bank_mask:0xf
    s_nop 0
    v_readlane_b32 s56, v17, 0
    v_readlane_b32 s57, v17, 16
    v_readlane_b32 s58, v17, 32
    v_readlane_b32 s59, v17, 48
    v_mov_b32 v17, s56
    v_add_f32 v17, s57, v17
    v_add_f32 v17, s58, v17
    v_add_f32 v17, s59, v17
    v_sub_f32 v20, v32, v16
    v_sub_f32 v21, v33, v16
    v_sub_f32 v22, v34, v16
    v_sub_f32 v23, v35, v16
    v_sub_f32 v24, v36, v16
    v_sub_f32 v25, v37, v16
    v_sub_f32 v26, v38, v16
    v_sub_f32 v27, v39, v16
    v_mul_f32 v17, 2.2321428571e-03, v17
    v_cvt_pk_bf16_f32 v17, v17, v17
    v_and_b32 v17, 0xffff0000, v17
    v_add_f32 v17, 0x3727c5ac, v17
    v_cvt_pk_bf16_f32 v17, v17, v17
    v_and_b32 v17, 0xffff0000, v17
    v_sqrt_f32 v17, v17
    v_cvt_pk_bf16_f32 v20, v20, v20
    v_and_b32 v20, 0xffff0000, v20
    v_cvt_pk_bf16_f32 v21, v21, v21
    v_and_b32 v21, 0xffff0000, v21
    v_cvt_pk_bf16_f32 v22, v22, v22
    v_and_b32 v22, 0xffff0000, v22
    v_cvt_pk_bf16_f32 v23, v23, v23
    v_and_b32 v23, 0xffff0000, v23
    v_cvt_pk_bf16_f32 v24, v24, v24
    v_and_b32 v24, 0xffff0000, v24
    v_cvt_pk_bf16_f32 v25, v25, v25
    v_and_b32 v25, 0xffff0000, v25
    v_cvt_pk_bf16_f32 v26, v26, v26
    v_and_b32 v26, 0xffff0000, v26
    v_cvt_pk_bf16_f32 v27, v27, v27
    v_and_b32 v27, 0xffff0000, v27
    v_cvt_pk_bf16_f32 v17, v17, v17
    v_and_b32 v17, 0xffff0000, v17
    v_rcp_f32 v17, v17
    s_nop 0
    v_mul_f32 v20, v20, v17
    v_mul_f32 v21, v21, v17
    v_mul_f32 v22, v22, v17
    v_mul_f32 v23, v23, v17
    v_mul_f32 v24, v24, v17
    v_mul_f32 v25, v25, v17
    v_mul_f32 v26, v26, v17
    v_mul_f32 v27, v27, v17
    v_cvt_pk_bf16_f32 v20, v20, v21
    v_cvt_pk_bf16_f32 v21, v22, v23
    v_cvt_pk_bf16_f32 v22, v24, v25
    v_cvt_pk_bf16_f32 v23, v26, v27
    ds_write_b64 v78, v[20:21] offset:30720
    ds_write_b64 v78, v[22:23] offset:31232
L_f1wait:
    s_waitcnt lgkmcnt(0)
    s_barrier
    ds_read_b128 v[40:43], v184 offset:30720
    ds_read_b128 v[44:47], v184 offset:30976
    ds_read_b128 v[48:51], v184 offset:31232
    ds_read_b128 v[52:55], v184 offset:31488
    ds_read_b32 v32, v189 offset:22528
    ds_read_b32 v33, v189 offset:22784
    ds_read_b32 v34, v189 offset:22592
    ds_read_b32 v35, v189 offset:22848
    s_waitcnt lgkmcnt(7)
    v_mfma_f32_16x16x32_bf16 v[168:171], v[80:83], v[40:43], v[168:171]
    v_mfma_f32_16x16x32_bf16 v[172:175], v[84:87], v[40:43], v[172:175]
    v_mfma_f32_16x16x32_bf16 v[176:179], v[88:91], v[40:43], v[176:179]
    v_mfma_f32_16x16x32_bf16 v[180:183], v[92:95], v[40:43], v[180:183]
    s_waitcnt lgkmcnt(6)
    v_mfma_f32_16x16x32_bf16 v[168:171], v[96:99], v[44:47], v[168:171]
    v_mfma_f32_16x16x32_bf16 v[172:175], v[100:103], v[44:47], v[172:175]
    v_mfma_f32_16x16x32_bf16 v[176:179], v[104:107], v[44:47], v[176:179]
    v_mfma_f32_16x16x32_bf16 v[180:183], v[108:111], v[44:47], v[180:183]
    s_waitcnt lgkmcnt(5)
    v_mfma_f32_16x16x32_bf16 v[168:171], v[112:115], v[48:51], v[168:171]
    v_mfma_f32_16x16x32_bf16 v[172:175], v[116:119], v[48:51], v[172:175]
    v_mfma_f32_16x16x32_bf16 v[176:179], v[120:123], v[48:51], v[176:179]
    v_mfma_f32_16x16x32_bf16 v[180:183], v[124:127], v[48:51], v[180:183]
    s_waitcnt lgkmcnt(4)
    v_mfma_f32_16x16x32_bf16 v[168:171], v[128:131], v[52:55], v[168:171]
    v_mfma_f32_16x16x32_bf16 v[172:175], v[132:135], v[52:55], v[172:175]
    s_nop 4
    v_add_f32_dpp v176, v180, v176 row_shl:4 row_mask:0xf bank_mask:0xf
    v_add_f32_dpp v177, v181, v177 row_shl:4 row_mask:0xf bank_mask:0xf
    v_add_f32_dpp v178, v182, v178 row_shl:4 row_mask:0xf bank_mask:0xf
    v_add_f32_dpp v179, v183, v179 row_shl:4 row_mask:0xf bank_mask:0xf
    v_add_f32_dpp v168, v172, v168 row_shl:4 row_mask:0xf bank_mask:0xf
    v_add_f32_dpp v169, v173, v169 row_shl:4 row_mask:0xf bank_mask:0xf
    v_add_f32_dpp v170, v174, v170 row_shl:4 row_mask:0xf bank_mask:0xf
    v_add_f32_dpp v171, v175, v171 row_shl:4 row_mask:0xf bank_mask:0xf
    v_add_f32_dpp v16, v176, v168 row_shl:8 row_mask:0xf bank_mask:0xf
    v_add_f32_dpp v17, v177, v169 row_shl:8 row_mask:0xf bank_mask:0xf
    v_add_f32_dpp v18, v178, v170 row_shl:8 row_mask:0xf bank_mask:0xf
    v_add_f32_dpp v19, v179, v171 row_shl:8 row_mask:0xf bank_mask:0xf
    v_cvt_pk_bf16_f32 v16, v16, v16
    v_and_b32 v16, 0xffff0000, v16
    v_cvt_pk_bf16_f32 v17, v17, v17
    v_and_b32 v17, 0xffff0000, v17
    v_cvt_pk_bf16_f32 v18, v18, v18
    v_and_b32 v18, 0xffff0000, v18
    v_cvt_pk_bf16_f32 v19, v19, v19
    v_and_b32 v19, 0xffff0000, v19
    v_permlane32_swap_b32 v16, v18
    s_nop 0
    v_permlane32_swap_b32 v17, v19
    v_mul_f32 v20, 0xbfb8aa3b, v16
    v_mul_f32 v21, 0xbfb8aa3b, v17
    v_exp_f32 v20, v20
    v_exp_f32 v21, v21
    v_add_f32 v20, 1.0, v20
    v_add_f32 v21, 1.0, v21
    v_rcp_f32 v20, v20
    v_rcp_f32 v21, v21
    v_mul_f32 v20, v20, v16
    v_mul_f32 v21, v21, v17
    v_cvt_pk_bf16_f32 v20, v20, v20
    v_and_b32 v20, 0xffff0000, v20
    v_cvt_pk_bf16_f32 v21, v21, v21
    v_and_b32 v21, 0xffff0000, v21
    v_mul_f32 v20, v20, v18
    v_mul_f32 v21, v21, v19
    v_cvt_pk_bf16_f32 v16, v20, v21
    s_mov_b32 exec_lo, 0x000f000f
    s_mov_b32 exec_hi, 0x000f000f
    ds_write_b32 v185, v16 offset:36864
    s_mov_b64 exec, -1
    v_mov_b32 v76, 0
    v_mov_b32 v77, 0
    v_mov_b32 v78, 0
    v_mov_b32 v79, 0
    s_mov_b32 s54, 200000
    s_waitcnt lgkmcnt(0)
    s_barrier
    s_cmp_eq_u32 s62, 7
    s_cbranch_scc1 L_pollo
    ds_read_b128 v[40:43], v186 offset:36864
    ds_read_b128 v[44:47], v186 offset:36928
    s_waitcnt lgkmcnt(1)
    v_mfma_f32_16x16x32_bf16 v[168:171], v[136:139], v[40:43], 0
    v_mfma_f32_16x16x32_bf16 v[172:175], v[144:147], v[40:43], 0
    v_mfma_f32_16x16x32_bf16 v[176:179], v[152:155], v[40:43], 0
    v_mfma_f32_16x16x32_bf16 v[180:183], v[160:163], v[40:43], 0
    s_waitcnt lgkmcnt(0)
    v_mfma_f32_16x16x32_bf16 v[168:171], v[140:143], v[44:47], v[168:171]
    v_mfma_f32_16x16x32_bf16 v[172:175], v[148:151], v[44:47], v[172:175]
    v_mfma_f32_16x16x32_bf16 v[176:179], v[156:159], v[44:47], v[176:179]
    v_mfma_f32_16x16x32_bf16 v[180:183], v[164:167], v[44:47], v[180:183]
    s_nop 5
    v_cndmask_b32 v168, v168, v172, s[72:73]
    v_cndmask_b32 v169, v169, v173, s[72:73]
    v_cndmask_b32 v170, v170, v174, s[72:73]
    v_cndmask_b32 v171, v171, v175, s[72:73]
    v_cndmask_b32 v168, v168, v176, s[74:75]
    v_cndmask_b32 v169, v169, v177, s[74:75]
    v_cndmask_b32 v170, v170, v178, s[74:75]
    v_cndmask_b32 v171, v171, v179, s[74:75]
    v_cndmask_b32 v168, v168, v180, s[76:77]
    v_cndmask_b32 v169, v169, v181, s[76:77]
    v_cndmask_b32 v170, v170, v182, s[76:77]
    v_cndmask_b32 v171, v171, v183, s[76:77]
    v_min_u32 v168, -2, v168
    v_min_u32 v169, -2, v169
    v_min_u32 v170, -2, v170
    v_min_u32 v171, -2, v171
    buffer_store_dwordx4 v[168:171], v187, s[12:15], s68 offen sc1
    s_cmp_eq_u32 s62, 6
    s_cbranch_scc0 L_done
L_pollo:
L_pollo1:
    buffer_load_dwordx4 v[64:67], v188, s[12:15], s69 offen offset:0 sc1
    buffer_load_dwordx4 v[68:71], v188, s[12:15], s69 offen offset:1024 sc1
    buffer_load_dwordx4 v[72:75], v188, s[12:15], s69 offen offset:2048 sc1
    s_mov_b32 exec_hi, 0
    buffer_load_dwordx4 v[76:79], v188, s[12:15], s69 offen offset:3072 sc1
    s_mov_b32 exec_hi, -1
    s_waitcnt vmcnt(0)
    v_max_u32 v16, v64, v65
    v_max3_u32 v16, v16, v66, v67
    v_max3_u32 v16, v16, v68, v69
    v_max3_u32 v16, v16, v70, v71
    v_max3_u32 v16, v16, v72, v73
    v_max3_u32 v16, v16, v74, v75
    v_max3_u32 v16, v16, v76, v77
    v_max3_u32 v16, v16, v78, v79
    v_cmp_eq_u32 vcc, -1, v16
    s_cmp_eq_u64 vcc, 0
    s_cbranch_scc1 L_goto0
    s_sub_u32 s54, s54, 1
    s_cmp_lg_u32 s54, 0
    s_cbranch_scc1 L_pollo1
L_goto0:
    v_add_f32 v40, v64, v72
    v_add_f32 v41, v65, v73
    v_add_f32 v42, v66, v74
    v_add_f32 v43, v67, v75
    v_add_f32 v44, v68, v76
    v_add_f32 v45, v69, v77
    v_add_f32 v46, v70, v78
    v_add_f32 v47, v71, v79
L_goto:
    v_add_f32 v40, v40, v44
    v_add_f32 v41, v41, v45
    v_add_f32 v42, v42, v46
    v_add_f32 v43, v43, v47
    v_add_f32_dpp v40, v40, v40 row_ror:8 row_mask:0xf bank_mask:0xf
    v_add_f32_dpp v41, v41, v41 row_ror:8 row_mask:0xf bank_mask:0xf
    v_add_f32_dpp v42, v42, v42 row_ror:8 row_mask:0xf bank_mask:0xf
    v_add_f32_dpp v43, v43, v43 row_ror:8 row_mask:0xf bank_mask:0xf
    v_mov_b32 v44, v40
    v_mov_b32 v45, v41
    v_mov_b32 v46, v42
    v_mov_b32 v47, v43
    v_permlane16_swap_b32 v40, v44
    v_permlane16_swap_b32 v41, v45
    v_permlane16_swap_b32 v42, v46
    v_permlane16_swap_b32 v43, v47
    v_add_f32 v40, v40, v44
    v_add_f32 v41, v41, v45
    v_add_f32 v42, v42, v46
    v_add_f32 v43, v43, v47
    v_mov_b32 v44, v40
    v_mov_b32 v45, v41
    v_mov_b32 v46, v42
    v_mov_b32 v47, v43
    v_permlane32_swap_b32 v40, v44
    v_permlane32_swap_b32 v41, v45
    v_permlane32_swap_b32 v42, v46
    v_permlane32_swap_b32 v43, v47
    v_add_f32 v40, v40, v44
    v_add_f32 v41, v41, v45
    v_add_f32 v42, v42, v46
    v_add_f32 v43, v43, v47
    v_cvt_pk_bf16_f32 v40, v40, v40
    v_and_b32 v40, 0xffff0000, v40
    v_cvt_pk_bf16_f32 v41, v41, v41
    v_and_b32 v41, 0xffff0000, v41
    v_cvt_pk_bf16_f32 v42, v42, v42
    v_and_b32 v42, 0xffff0000, v42
    v_cvt_pk_bf16_f32 v43, v43, v43
    v_and_b32 v43, 0xffff0000, v43
    v_add_f32 v40, v40, v32
    v_add_f32 v41, v41, v33
    v_add_f32 v42, v42, v34
    v_add_f32 v43, v43, v35
    v_cvt_pk_bf16_f32 v18, v40, v41
    v_cvt_pk_bf16_f32 v19, v42, v43
    s_mov_b64 exec, 0xff
    buffer_store_dwordx2 v[18:19], v190, s[44:47], 0 offen
    s_mov_b64 exec, -1
L_done:
    s_endpgm
.section .rodata,"a"
.p2align 6
.amdhsa_kernel sequential_preLN__mha_block_cached__glu_gated_swiglu__decode_kernel
  .amdhsa_next_free_vgpr 256
  .amdhsa_next_free_sgpr 102
  .amdhsa_accum_offset 256
  .amdhsa_group_segment_fixed_size 0
  .amdhsa_kernarg_size 96
  .amdhsa_user_sgpr_count 2
  .amdhsa_user_sgpr_kernarg_segment_ptr 1
  .amdhsa_system_sgpr_workgroup_id_x 1
.end_amdhsa_kernel
```
